```python
import torch

def _softmax(x, axis=-1):
    return torch.softmax(x, dim=axis)

def _gelu(x):
    return torch.nn.functional.gelu(x, approximate='tanh')

def _silu(x):
    return torch.nn.functional.silu(x)

def _sigmoid(x):
    return torch.sigmoid(x)

def _layernorm(x, axis=-1, eps=1e-05):
    m = x.mean(dim=axis, keepdim=True)
    v = x.var(dim=axis, keepdim=True, unbiased=False)
    return (x - m) / torch.sqrt(v + eps)

def _scatter_add(tgt, idx, src, axis=0):
    return tgt.clone().index_add_(axis, idx, src)

def _segment_sum(src, seg, n):
    out = torch.zeros((n,) + src.shape[1:], dtype=src.dtype)
    return out.index_add_(0, seg, src)

def _pad(x, pw):
    flat = tuple((v for pair in reversed(pw) for v in pair))
    return torch.nn.functional.pad(x, flat)
kernel_name = 'parallel_sum__memory_aug_recurrent_mem_tr__mixer_channel_mlp__prompt'

def setup_inputs():

    _w = lambda a: (lambda t: t.to(torch.bfloat16) if t.is_floating_point() else t)(torch.as_tensor(a))

    def _A_setup():
        B, S, Dm = (1, 2048, 1024)
        H, Dh = (32, 128)
        M, seg = (8, 32)
        seg = min(seg, S)
        S = S // seg * seg
        return {'x': _w((lambda *s: torch.randn(*s, dtype=torch.bfloat16) * 0.05)(B, S, Dm)), 'mem0': _w((lambda *s: torch.randn(*s, dtype=torch.bfloat16) * 0.2)(B, M, Dm)), 'Wq': _w((lambda *s: torch.randn(*s, dtype=torch.bfloat16) * 1.6)(Dm, H, Dh) * Dm ** (-0.5)), 'Wk': _w((lambda *s: torch.randn(*s, dtype=torch.bfloat16) * 1.6)(Dm, H, Dh) * Dm ** (-0.5)), 'Wv': _w((lambda *s: torch.randn(*s, dtype=torch.bfloat16) * 0.2)(Dm, H, Dh) * Dm ** (-0.5)), 'Wo': _w((lambda *s: torch.randn(*s, dtype=torch.bfloat16) * 0.2)(H, Dh, Dm) * (H * Dh) ** (-0.5)), 'seg_len': seg}
    _A_in = _A_setup()

    def _B_setup():
        B, S, D, F = (1, 2048, 1024, 3584)
        return {'x': _w((lambda *s: torch.randn(*s, dtype=torch.bfloat16) * 0.05)(B, S, D)), 'w1': _w((lambda *s: torch.randn(*s, dtype=torch.bfloat16) * 1.6)(D, F) * D ** (-0.5)), 'b1': _w((lambda *s: torch.randn(*s, dtype=torch.bfloat16) * 0.4)(F)), 'w2': _w((lambda *s: torch.randn(*s, dtype=torch.bfloat16) * 0.05)(F, D) * F ** (-0.5)), 'b2': _w((lambda *s: torch.randn(*s, dtype=torch.bfloat16) * 0.05)(D))}
    _B_in = _B_setup()
    return {'A_x': _A_in['x'], 'A_mem0': _A_in['mem0'], 'A_Wq': _A_in['Wq'], 'A_Wk': _A_in['Wk'], 'A_Wv': _A_in['Wv'], 'A_Wo': _A_in['Wo'], 'A_seg_len': _A_in['seg_len'], 'B_x': _B_in['x'], 'B_w1': _B_in['w1'], 'B_b1': _B_in['b1'], 'B_w2': _B_in['w2'], 'B_b2': _B_in['b2']}

def reference(A_x, A_mem0, A_Wq, A_Wk, A_Wv, A_Wo, A_seg_len, B_x, B_w1, B_b1, B_w2, B_b2):

    def _A_ref(x, mem0, Wq, Wk, Wv, Wo, seg_len):
        B, S, Dm = x.shape
        H, Dh = (Wq.shape[1], Wq.shape[2])
        M = mem0.shape[1]
        scale = Dh ** (-0.5)
        n_seg = S // seg_len
        L = M + seg_len
        idx = torch.arange(L)
        mask = (idx[:, None] < M) | (idx[:, None] >= idx[None, :])
        mem = mem0
        outs = []
        for s in range(n_seg):
            xs = x[:, s * seg_len:(s + 1) * seg_len, :].clone()
            h = torch.concatenate([mem, xs], axis=1)
            q = torch.einsum('btd,dhe->bhte', h, Wq)
            k = torch.einsum('btd,dhe->bhte', h, Wk)
            v = torch.einsum('btd,dhe->bhte', h, Wv)
            scores = torch.einsum('bhqe,bhke->bhqk', q, k) * scale
            scores = torch.where(mask[None, None], scores, -1000000000.0)
            p = _softmax(scores, axis=-1)
            o = torch.einsum('bhqk,bhke->bhqe', p, v)
            o = torch.einsum('bhte,hed->btd', o, Wo)
            mem = o[:, :M, :].clone()
            outs.append(o[:, M:, :])
        return torch.concatenate(outs, axis=1)

    def _B_ref(x, w1, b1, w2, b2):
        y = _layernorm(x, axis=-1)
        h = _gelu(torch.einsum('bsd,df->bsf', y, w1) + b1)
        return torch.einsum('bsf,fd->bsd', h, w2) + b2
    x = A_x
    xn = _layernorm(x, axis=-1)
    return x + _A_ref(xn, A_mem0, A_Wq, A_Wk, A_Wv, A_Wo, A_seg_len) + _B_ref(xn, B_w1, B_b1, B_w2, B_b2)
```

```asm
; @launch kernel=prep_kernel grid=(1260,1,1) block=(256,1,1) lds=0
; @launch kernel=chain_kernel grid=(256,1,1) block=(512,1,1) lds=118800
; @launch kernel=attn_kernel grid=(512,1,1) block=(256,1,1) lds=55296
; @launch kernel=gemm2_kernel grid=(256,1,1) block=(256,1,1) lds=61440
.amdgcn_target "amdgcn-amd-amdhsa--gfx950"
.text
.globl prep_kernel
.p2align 8
.type prep_kernel,@function
prep_kernel:
    s_load_dwordx2 s[4:5], s[0:1], 0
    s_mov_b32 s6, 4194304
    s_mov_b32 s7, 0x00020000
    s_load_dwordx2 s[8:9], s[0:1], 112
    s_mov_b32 s10, 268435456
    s_mov_b32 s11, 0x00020000
    s_cmp_ge_u32 s2, 1260
    s_cbranch_scc1 prep_done
    s_waitcnt lgkmcnt(0)
    s_cmp_ge_u32 s2, 512
    s_cbranch_scc1 prep_zero
    v_and_b32 v1, 63, v0
    v_lshlrev_b32 v2, 2, v1
    v_lshrrev_b32 v3, 6, v0
    s_lshl_b32 s3, s2, 2
    v_add_u32 v3, s3, v3
    v_lshlrev_b32 v3, 11, v3
    v_lshl_add_u32 v3, v1, 5, v3
    buffer_load_dwordx4 v[4:7], v3, s[4:7], 0 offen
    buffer_load_dwordx4 v[8:11], v3, s[4:7], 0 offen offset:16
    s_waitcnt vmcnt(0)
    v_lshlrev_b32 v16, 16, v4
    v_and_b32 v17, 0xffff0000, v4
    v_lshlrev_b32 v18, 16, v5
    v_and_b32 v19, 0xffff0000, v5
    v_lshlrev_b32 v20, 16, v6
    v_and_b32 v21, 0xffff0000, v6
    v_lshlrev_b32 v22, 16, v7
    v_and_b32 v23, 0xffff0000, v7
    v_lshlrev_b32 v24, 16, v8
    v_and_b32 v25, 0xffff0000, v8
    v_lshlrev_b32 v26, 16, v9
    v_and_b32 v27, 0xffff0000, v9
    v_lshlrev_b32 v28, 16, v10
    v_and_b32 v29, 0xffff0000, v10
    v_lshlrev_b32 v30, 16, v11
    v_and_b32 v31, 0xffff0000, v11
    v_add_f32 v41, v16, v17
    v_add_f32 v41, v41, v18
    v_add_f32 v41, v41, v19
    v_add_f32 v41, v41, v20
    v_add_f32 v41, v41, v21
    v_add_f32 v41, v41, v22
    v_add_f32 v41, v41, v23
    v_add_f32 v41, v41, v24
    v_add_f32 v41, v41, v25
    v_add_f32 v41, v41, v26
    v_add_f32 v41, v41, v27
    v_add_f32 v41, v41, v28
    v_add_f32 v41, v41, v29
    v_add_f32 v41, v41, v30
    v_add_f32 v41, v41, v31
    v_xor_b32 v42, 4, v2
    ds_bpermute_b32 v40, v42, v41
    s_waitcnt lgkmcnt(0)
    v_add_f32 v41, v41, v40
    v_xor_b32 v42, 8, v2
    ds_bpermute_b32 v40, v42, v41
    s_waitcnt lgkmcnt(0)
    v_add_f32 v41, v41, v40
    v_xor_b32 v42, 16, v2
    ds_bpermute_b32 v40, v42, v41
    s_waitcnt lgkmcnt(0)
    v_add_f32 v41, v41, v40
    v_xor_b32 v42, 32, v2
    ds_bpermute_b32 v40, v42, v41
    s_waitcnt lgkmcnt(0)
    v_add_f32 v41, v41, v40
    v_xor_b32 v42, 64, v2
    ds_bpermute_b32 v40, v42, v41
    s_waitcnt lgkmcnt(0)
    v_add_f32 v41, v41, v40
    v_xor_b32 v42, 128, v2
    ds_bpermute_b32 v40, v42, v41
    s_waitcnt lgkmcnt(0)
    v_add_f32 v41, v41, v40
    v_mul_f32 v43, 0x3a800000, v41
    v_mov_b32 v41, 0
    v_sub_f32 v40, v16, v43
    v_fmac_f32 v41, v40, v40
    v_sub_f32 v40, v17, v43
    v_fmac_f32 v41, v40, v40
    v_sub_f32 v40, v18, v43
    v_fmac_f32 v41, v40, v40
    v_sub_f32 v40, v19, v43
    v_fmac_f32 v41, v40, v40
    v_sub_f32 v40, v20, v43
    v_fmac_f32 v41, v40, v40
    v_sub_f32 v40, v21, v43
    v_fmac_f32 v41, v40, v40
    v_sub_f32 v40, v22, v43
    v_fmac_f32 v41, v40, v40
    v_sub_f32 v40, v23, v43
    v_fmac_f32 v41, v40, v40
    v_sub_f32 v40, v24, v43
    v_fmac_f32 v41, v40, v40
    v_sub_f32 v40, v25, v43
    v_fmac_f32 v41, v40, v40
    v_sub_f32 v40, v26, v43
    v_fmac_f32 v41, v40, v40
    v_sub_f32 v40, v27, v43
    v_fmac_f32 v41, v40, v40
    v_sub_f32 v40, v28, v43
    v_fmac_f32 v41, v40, v40
    v_sub_f32 v40, v29, v43
    v_fmac_f32 v41, v40, v40
    v_sub_f32 v40, v30, v43
    v_fmac_f32 v41, v40, v40
    v_sub_f32 v40, v31, v43
    v_fmac_f32 v41, v40, v40
    v_xor_b32 v42, 4, v2
    ds_bpermute_b32 v40, v42, v41
    s_waitcnt lgkmcnt(0)
    v_add_f32 v41, v41, v40
    v_xor_b32 v42, 8, v2
    ds_bpermute_b32 v40, v42, v41
    s_waitcnt lgkmcnt(0)
    v_add_f32 v41, v41, v40
    v_xor_b32 v42, 16, v2
    ds_bpermute_b32 v40, v42, v41
    s_waitcnt lgkmcnt(0)
    v_add_f32 v41, v41, v40
    v_xor_b32 v42, 32, v2
    ds_bpermute_b32 v40, v42, v41
    s_waitcnt lgkmcnt(0)
    v_add_f32 v41, v41, v40
    v_xor_b32 v42, 64, v2
    ds_bpermute_b32 v40, v42, v41
    s_waitcnt lgkmcnt(0)
    v_add_f32 v41, v41, v40
    v_xor_b32 v42, 128, v2
    ds_bpermute_b32 v40, v42, v41
    s_waitcnt lgkmcnt(0)
    v_add_f32 v41, v41, v40
    v_mul_f32 v41, 0x3a800000, v41
    v_cvt_pk_bf16_f32 v40, v41, v41
    v_lshlrev_b32 v41, 16, v40
    v_cvt_pk_bf16_f32 v40, v43, v43
    v_lshlrev_b32 v43, 16, v40
    v_add_f32 v41, 0x3727c5ac, v41
    v_cvt_pk_bf16_f32 v40, v41, v41
    v_lshlrev_b32 v41, 16, v40
    v_sqrt_f32 v44, v41
    s_nop 0
    v_cvt_pk_bf16_f32 v40, v44, v44
    v_lshlrev_b32 v44, 16, v40
    v_rcp_f32 v45, v44
    s_nop 0
    v_sub_f32 v16, v16, v43
    v_cvt_pk_bf16_f32 v40, v16, v16
    v_lshlrev_b32 v16, 16, v40
    v_mul_f32 v40, v16, v45
    v_fma_f32 v41, -v40, v44, v16
    v_fma_f32 v16, v41, v45, v40
    v_cvt_pk_bf16_f32 v40, v16, v16
    v_lshlrev_b32 v16, 16, v40
    v_sub_f32 v17, v17, v43
    v_cvt_pk_bf16_f32 v40, v17, v17
    v_lshlrev_b32 v17, 16, v40
    v_mul_f32 v40, v17, v45
    v_fma_f32 v41, -v40, v44, v17
    v_fma_f32 v17, v41, v45, v40
    v_cvt_pk_bf16_f32 v40, v17, v17
    v_lshlrev_b32 v17, 16, v40
    v_sub_f32 v18, v18, v43
    v_cvt_pk_bf16_f32 v40, v18, v18
    v_lshlrev_b32 v18, 16, v40
    v_mul_f32 v40, v18, v45
    v_fma_f32 v41, -v40, v44, v18
    v_fma_f32 v18, v41, v45, v40
    v_cvt_pk_bf16_f32 v40, v18, v18
    v_lshlrev_b32 v18, 16, v40
    v_sub_f32 v19, v19, v43
    v_cvt_pk_bf16_f32 v40, v19, v19
    v_lshlrev_b32 v19, 16, v40
    v_mul_f32 v40, v19, v45
    v_fma_f32 v41, -v40, v44, v19
    v_fma_f32 v19, v41, v45, v40
    v_cvt_pk_bf16_f32 v40, v19, v19
    v_lshlrev_b32 v19, 16, v40
    v_sub_f32 v20, v20, v43
    v_cvt_pk_bf16_f32 v40, v20, v20
    v_lshlrev_b32 v20, 16, v40
    v_mul_f32 v40, v20, v45
    v_fma_f32 v41, -v40, v44, v20
    v_fma_f32 v20, v41, v45, v40
    v_cvt_pk_bf16_f32 v40, v20, v20
    v_lshlrev_b32 v20, 16, v40
    v_sub_f32 v21, v21, v43
    v_cvt_pk_bf16_f32 v40, v21, v21
    v_lshlrev_b32 v21, 16, v40
    v_mul_f32 v40, v21, v45
    v_fma_f32 v41, -v40, v44, v21
    v_fma_f32 v21, v41, v45, v40
    v_cvt_pk_bf16_f32 v40, v21, v21
    v_lshlrev_b32 v21, 16, v40
    v_sub_f32 v22, v22, v43
    v_cvt_pk_bf16_f32 v40, v22, v22
    v_lshlrev_b32 v22, 16, v40
    v_mul_f32 v40, v22, v45
    v_fma_f32 v41, -v40, v44, v22
    v_fma_f32 v22, v41, v45, v40
    v_cvt_pk_bf16_f32 v40, v22, v22
    v_lshlrev_b32 v22, 16, v40
    v_sub_f32 v23, v23, v43
    v_cvt_pk_bf16_f32 v40, v23, v23
    v_lshlrev_b32 v23, 16, v40
    v_mul_f32 v40, v23, v45
    v_fma_f32 v41, -v40, v44, v23
    v_fma_f32 v23, v41, v45, v40
    v_cvt_pk_bf16_f32 v40, v23, v23
    v_lshlrev_b32 v23, 16, v40
    v_sub_f32 v24, v24, v43
    v_cvt_pk_bf16_f32 v40, v24, v24
    v_lshlrev_b32 v24, 16, v40
    v_mul_f32 v40, v24, v45
    v_fma_f32 v41, -v40, v44, v24
    v_fma_f32 v24, v41, v45, v40
    v_cvt_pk_bf16_f32 v40, v24, v24
    v_lshlrev_b32 v24, 16, v40
    v_sub_f32 v25, v25, v43
    v_cvt_pk_bf16_f32 v40, v25, v25
    v_lshlrev_b32 v25, 16, v40
    v_mul_f32 v40, v25, v45
    v_fma_f32 v41, -v40, v44, v25
    v_fma_f32 v25, v41, v45, v40
    v_cvt_pk_bf16_f32 v40, v25, v25
    v_lshlrev_b32 v25, 16, v40
    v_sub_f32 v26, v26, v43
    v_cvt_pk_bf16_f32 v40, v26, v26
    v_lshlrev_b32 v26, 16, v40
    v_mul_f32 v40, v26, v45
    v_fma_f32 v41, -v40, v44, v26
    v_fma_f32 v26, v41, v45, v40
    v_cvt_pk_bf16_f32 v40, v26, v26
    v_lshlrev_b32 v26, 16, v40
    v_sub_f32 v27, v27, v43
    v_cvt_pk_bf16_f32 v40, v27, v27
    v_lshlrev_b32 v27, 16, v40
    v_mul_f32 v40, v27, v45
    v_fma_f32 v41, -v40, v44, v27
    v_fma_f32 v27, v41, v45, v40
    v_cvt_pk_bf16_f32 v40, v27, v27
    v_lshlrev_b32 v27, 16, v40
    v_sub_f32 v28, v28, v43
    v_cvt_pk_bf16_f32 v40, v28, v28
    v_lshlrev_b32 v28, 16, v40
    v_mul_f32 v40, v28, v45
    v_fma_f32 v41, -v40, v44, v28
    v_fma_f32 v28, v41, v45, v40
    v_cvt_pk_bf16_f32 v40, v28, v28
    v_lshlrev_b32 v28, 16, v40
    v_sub_f32 v29, v29, v43
    v_cvt_pk_bf16_f32 v40, v29, v29
    v_lshlrev_b32 v29, 16, v40
    v_mul_f32 v40, v29, v45
    v_fma_f32 v41, -v40, v44, v29
    v_fma_f32 v29, v41, v45, v40
    v_cvt_pk_bf16_f32 v40, v29, v29
    v_lshlrev_b32 v29, 16, v40
    v_sub_f32 v30, v30, v43
    v_cvt_pk_bf16_f32 v40, v30, v30
    v_lshlrev_b32 v30, 16, v40
    v_mul_f32 v40, v30, v45
    v_fma_f32 v41, -v40, v44, v30
    v_fma_f32 v30, v41, v45, v40
    v_cvt_pk_bf16_f32 v40, v30, v30
    v_lshlrev_b32 v30, 16, v40
    v_sub_f32 v31, v31, v43
    v_cvt_pk_bf16_f32 v40, v31, v31
    v_lshlrev_b32 v31, 16, v40
    v_mul_f32 v40, v31, v45
    v_fma_f32 v41, -v40, v44, v31
    v_fma_f32 v31, v41, v45, v40
    v_cvt_pk_bf16_f32 v40, v31, v31
    v_lshlrev_b32 v31, 16, v40
    v_cvt_pk_bf16_f32 v4, v16, v17
    v_cvt_pk_bf16_f32 v5, v18, v19
    v_cvt_pk_bf16_f32 v6, v20, v21
    v_cvt_pk_bf16_f32 v7, v22, v23
    v_cvt_pk_bf16_f32 v8, v24, v25
    v_cvt_pk_bf16_f32 v9, v26, v27
    v_cvt_pk_bf16_f32 v10, v28, v29
    v_cvt_pk_bf16_f32 v11, v30, v31
    s_mov_b32 s12, 0
    buffer_store_dwordx4 v[4:7], v3, s[8:11], s12 offen
    buffer_store_dwordx4 v[8:11], v3, s[8:11], s12 offen offset:16
    s_nop 1
    v_add_f32 v41, v16, v17
    v_add_f32 v41, v41, v18
    v_add_f32 v41, v41, v19
    v_add_f32 v41, v41, v20
    v_add_f32 v41, v41, v21
    v_add_f32 v41, v41, v22
    v_add_f32 v41, v41, v23
    v_add_f32 v41, v41, v24
    v_add_f32 v41, v41, v25
    v_add_f32 v41, v41, v26
    v_add_f32 v41, v41, v27
    v_add_f32 v41, v41, v28
    v_add_f32 v41, v41, v29
    v_add_f32 v41, v41, v30
    v_add_f32 v41, v41, v31
    v_xor_b32 v42, 4, v2
    ds_bpermute_b32 v40, v42, v41
    s_waitcnt lgkmcnt(0)
    v_add_f32 v41, v41, v40
    v_xor_b32 v42, 8, v2
    ds_bpermute_b32 v40, v42, v41
    s_waitcnt lgkmcnt(0)
    v_add_f32 v41, v41, v40
    v_xor_b32 v42, 16, v2
    ds_bpermute_b32 v40, v42, v41
    s_waitcnt lgkmcnt(0)
    v_add_f32 v41, v41, v40
    v_xor_b32 v42, 32, v2
    ds_bpermute_b32 v40, v42, v41
    s_waitcnt lgkmcnt(0)
    v_add_f32 v41, v41, v40
    v_xor_b32 v42, 64, v2
    ds_bpermute_b32 v40, v42, v41
    s_waitcnt lgkmcnt(0)
    v_add_f32 v41, v41, v40
    v_xor_b32 v42, 128, v2
    ds_bpermute_b32 v40, v42, v41
    s_waitcnt lgkmcnt(0)
    v_add_f32 v41, v41, v40
    v_mul_f32 v43, 0x3a800000, v41
    v_mov_b32 v41, 0
    v_sub_f32 v40, v16, v43
    v_fmac_f32 v41, v40, v40
    v_sub_f32 v40, v17, v43
    v_fmac_f32 v41, v40, v40
    v_sub_f32 v40, v18, v43
    v_fmac_f32 v41, v40, v40
    v_sub_f32 v40, v19, v43
    v_fmac_f32 v41, v40, v40
    v_sub_f32 v40, v20, v43
    v_fmac_f32 v41, v40, v40
    v_sub_f32 v40, v21, v43
    v_fmac_f32 v41, v40, v40
    v_sub_f32 v40, v22, v43
    v_fmac_f32 v41, v40, v40
    v_sub_f32 v40, v23, v43
    v_fmac_f32 v41, v40, v40
    v_sub_f32 v40, v24, v43
    v_fmac_f32 v41, v40, v40
    v_sub_f32 v40, v25, v43
    v_fmac_f32 v41, v40, v40
    v_sub_f32 v40, v26, v43
    v_fmac_f32 v41, v40, v40
    v_sub_f32 v40, v27, v43
    v_fmac_f32 v41, v40, v40
    v_sub_f32 v40, v28, v43
    v_fmac_f32 v41, v40, v40
    v_sub_f32 v40, v29, v43
    v_fmac_f32 v41, v40, v40
    v_sub_f32 v40, v30, v43
    v_fmac_f32 v41, v40, v40
    v_sub_f32 v40, v31, v43
    v_fmac_f32 v41, v40, v40
    v_xor_b32 v42, 4, v2
    ds_bpermute_b32 v40, v42, v41
    s_waitcnt lgkmcnt(0)
    v_add_f32 v41, v41, v40
    v_xor_b32 v42, 8, v2
    ds_bpermute_b32 v40, v42, v41
    s_waitcnt lgkmcnt(0)
    v_add_f32 v41, v41, v40
    v_xor_b32 v42, 16, v2
    ds_bpermute_b32 v40, v42, v41
    s_waitcnt lgkmcnt(0)
    v_add_f32 v41, v41, v40
    v_xor_b32 v42, 32, v2
    ds_bpermute_b32 v40, v42, v41
    s_waitcnt lgkmcnt(0)
    v_add_f32 v41, v41, v40
    v_xor_b32 v42, 64, v2
    ds_bpermute_b32 v40, v42, v41
    s_waitcnt lgkmcnt(0)
    v_add_f32 v41, v41, v40
    v_xor_b32 v42, 128, v2
    ds_bpermute_b32 v40, v42, v41
    s_waitcnt lgkmcnt(0)
    v_add_f32 v41, v41, v40
    v_mul_f32 v41, 0x3a800000, v41
    v_cvt_pk_bf16_f32 v40, v41, v41
    v_lshlrev_b32 v41, 16, v40
    v_cvt_pk_bf16_f32 v40, v43, v43
    v_lshlrev_b32 v43, 16, v40
    v_add_f32 v41, 0x3727c5ac, v41
    v_cvt_pk_bf16_f32 v40, v41, v41
    v_lshlrev_b32 v41, 16, v40
    v_sqrt_f32 v44, v41
    s_nop 0
    v_cvt_pk_bf16_f32 v40, v44, v44
    v_lshlrev_b32 v44, 16, v40
    v_rcp_f32 v45, v44
    s_nop 0
    v_sub_f32 v16, v16, v43
    v_cvt_pk_bf16_f32 v40, v16, v16
    v_lshlrev_b32 v16, 16, v40
    v_mul_f32 v40, v16, v45
    v_fma_f32 v41, -v40, v44, v16
    v_fma_f32 v16, v41, v45, v40
    v_cvt_pk_bf16_f32 v40, v16, v16
    v_lshlrev_b32 v16, 16, v40
    v_sub_f32 v17, v17, v43
    v_cvt_pk_bf16_f32 v40, v17, v17
    v_lshlrev_b32 v17, 16, v40
    v_mul_f32 v40, v17, v45
    v_fma_f32 v41, -v40, v44, v17
    v_fma_f32 v17, v41, v45, v40
    v_cvt_pk_bf16_f32 v40, v17, v17
    v_lshlrev_b32 v17, 16, v40
    v_sub_f32 v18, v18, v43
    v_cvt_pk_bf16_f32 v40, v18, v18
    v_lshlrev_b32 v18, 16, v40
    v_mul_f32 v40, v18, v45
    v_fma_f32 v41, -v40, v44, v18
    v_fma_f32 v18, v41, v45, v40
    v_cvt_pk_bf16_f32 v40, v18, v18
    v_lshlrev_b32 v18, 16, v40
    v_sub_f32 v19, v19, v43
    v_cvt_pk_bf16_f32 v40, v19, v19
    v_lshlrev_b32 v19, 16, v40
    v_mul_f32 v40, v19, v45
    v_fma_f32 v41, -v40, v44, v19
    v_fma_f32 v19, v41, v45, v40
    v_cvt_pk_bf16_f32 v40, v19, v19
    v_lshlrev_b32 v19, 16, v40
    v_sub_f32 v20, v20, v43
    v_cvt_pk_bf16_f32 v40, v20, v20
    v_lshlrev_b32 v20, 16, v40
    v_mul_f32 v40, v20, v45
    v_fma_f32 v41, -v40, v44, v20
    v_fma_f32 v20, v41, v45, v40
    v_cvt_pk_bf16_f32 v40, v20, v20
    v_lshlrev_b32 v20, 16, v40
    v_sub_f32 v21, v21, v43
    v_cvt_pk_bf16_f32 v40, v21, v21
    v_lshlrev_b32 v21, 16, v40
    v_mul_f32 v40, v21, v45
    v_fma_f32 v41, -v40, v44, v21
    v_fma_f32 v21, v41, v45, v40
    v_cvt_pk_bf16_f32 v40, v21, v21
    v_lshlrev_b32 v21, 16, v40
    v_sub_f32 v22, v22, v43
    v_cvt_pk_bf16_f32 v40, v22, v22
    v_lshlrev_b32 v22, 16, v40
    v_mul_f32 v40, v22, v45
    v_fma_f32 v41, -v40, v44, v22
    v_fma_f32 v22, v41, v45, v40
    v_cvt_pk_bf16_f32 v40, v22, v22
    v_lshlrev_b32 v22, 16, v40
    v_sub_f32 v23, v23, v43
    v_cvt_pk_bf16_f32 v40, v23, v23
    v_lshlrev_b32 v23, 16, v40
    v_mul_f32 v40, v23, v45
    v_fma_f32 v41, -v40, v44, v23
    v_fma_f32 v23, v41, v45, v40
    v_cvt_pk_bf16_f32 v40, v23, v23
    v_lshlrev_b32 v23, 16, v40
    v_sub_f32 v24, v24, v43
    v_cvt_pk_bf16_f32 v40, v24, v24
    v_lshlrev_b32 v24, 16, v40
    v_mul_f32 v40, v24, v45
    v_fma_f32 v41, -v40, v44, v24
    v_fma_f32 v24, v41, v45, v40
    v_cvt_pk_bf16_f32 v40, v24, v24
    v_lshlrev_b32 v24, 16, v40
    v_sub_f32 v25, v25, v43
    v_cvt_pk_bf16_f32 v40, v25, v25
    v_lshlrev_b32 v25, 16, v40
    v_mul_f32 v40, v25, v45
    v_fma_f32 v41, -v40, v44, v25
    v_fma_f32 v25, v41, v45, v40
    v_cvt_pk_bf16_f32 v40, v25, v25
    v_lshlrev_b32 v25, 16, v40
    v_sub_f32 v26, v26, v43
    v_cvt_pk_bf16_f32 v40, v26, v26
    v_lshlrev_b32 v26, 16, v40
    v_mul_f32 v40, v26, v45
    v_fma_f32 v41, -v40, v44, v26
    v_fma_f32 v26, v41, v45, v40
    v_cvt_pk_bf16_f32 v40, v26, v26
    v_lshlrev_b32 v26, 16, v40
    v_sub_f32 v27, v27, v43
    v_cvt_pk_bf16_f32 v40, v27, v27
    v_lshlrev_b32 v27, 16, v40
    v_mul_f32 v40, v27, v45
    v_fma_f32 v41, -v40, v44, v27
    v_fma_f32 v27, v41, v45, v40
    v_cvt_pk_bf16_f32 v40, v27, v27
    v_lshlrev_b32 v27, 16, v40
    v_sub_f32 v28, v28, v43
    v_cvt_pk_bf16_f32 v40, v28, v28
    v_lshlrev_b32 v28, 16, v40
    v_mul_f32 v40, v28, v45
    v_fma_f32 v41, -v40, v44, v28
    v_fma_f32 v28, v41, v45, v40
    v_cvt_pk_bf16_f32 v40, v28, v28
    v_lshlrev_b32 v28, 16, v40
    v_sub_f32 v29, v29, v43
    v_cvt_pk_bf16_f32 v40, v29, v29
    v_lshlrev_b32 v29, 16, v40
    v_mul_f32 v40, v29, v45
    v_fma_f32 v41, -v40, v44, v29
    v_fma_f32 v29, v41, v45, v40
    v_cvt_pk_bf16_f32 v40, v29, v29
    v_lshlrev_b32 v29, 16, v40
    v_sub_f32 v30, v30, v43
    v_cvt_pk_bf16_f32 v40, v30, v30
    v_lshlrev_b32 v30, 16, v40
    v_mul_f32 v40, v30, v45
    v_fma_f32 v41, -v40, v44, v30
    v_fma_f32 v30, v41, v45, v40
    v_cvt_pk_bf16_f32 v40, v30, v30
    v_lshlrev_b32 v30, 16, v40
    v_sub_f32 v31, v31, v43
    v_cvt_pk_bf16_f32 v40, v31, v31
    v_lshlrev_b32 v31, 16, v40
    v_mul_f32 v40, v31, v45
    v_fma_f32 v41, -v40, v44, v31
    v_fma_f32 v31, v41, v45, v40
    v_cvt_pk_bf16_f32 v40, v31, v31
    v_lshlrev_b32 v31, 16, v40
    v_cvt_pk_bf16_f32 v4, v16, v17
    v_cvt_pk_bf16_f32 v5, v18, v19
    v_cvt_pk_bf16_f32 v6, v20, v21
    v_cvt_pk_bf16_f32 v7, v22, v23
    v_cvt_pk_bf16_f32 v8, v24, v25
    v_cvt_pk_bf16_f32 v9, v26, v27
    v_cvt_pk_bf16_f32 v10, v28, v29
    v_cvt_pk_bf16_f32 v11, v30, v31
    s_mov_b32 s12, 4194304
    buffer_store_dwordx4 v[4:7], v3, s[8:11], s12 offen
    buffer_store_dwordx4 v[8:11], v3, s[8:11], s12 offen offset:16
    s_nop 1
    s_branch prep_done
prep_zero:
    s_sub_u32 s3, s2, 512
    s_lshl_b32 s3, s3, 12
    s_add_u32 s3, s3, 100663296
    v_lshlrev_b32 v1, 4, v0
    v_mov_b32 v4, 0
    v_mov_b32 v5, 0
    v_mov_b32 v6, 0
    v_mov_b32 v7, 0
    buffer_store_dwordx4 v[4:7], v1, s[8:11], s3 offen
prep_done:
    s_endpgm
.globl chain_kernel
.p2align 8
.type chain_kernel,@function
chain_kernel:
    s_cmp_ge_u32 s2, 256
    s_cbranch_scc1 ch_done
    s_cmp_ge_u32 s2, 128
    s_cbranch_scc1 wk_entry
    s_load_dwordx2 s[8:9], s[0:1], 112
    s_mov_b32 s10, 268435456
    s_mov_b32 s11, 0x00020000
    s_load_dwordx2 s[12:13], s[0:1], 16
    s_mov_b32 s14, 8388608
    s_mov_b32 s15, 0x00020000
    s_load_dwordx2 s[16:17], s[0:1], 24
    s_mov_b32 s18, 8388608
    s_mov_b32 s19, 0x00020000
    s_load_dwordx2 s[20:21], s[0:1], 32
    s_mov_b32 s22, 8388608
    s_mov_b32 s23, 0x00020000
    s_load_dwordx2 s[24:25], s[0:1], 40
    s_mov_b32 s26, 8388608
    s_mov_b32 s27, 0x00020000
    s_load_dwordx2 s[28:29], s[0:1], 8
    s_mov_b32 s30, 16384
    s_mov_b32 s31, 0x00020000
    s_and_b32 s32, s2, 7
    s_lshr_b32 s33, s2, 3
    s_lshr_b32 s34, s33, 2
    s_lshl_b32 s35, s32, 2
    s_add_u32 s34, s34, s35
    s_and_b32 s35, s33, 3
    v_and_b32 v1, 63, v0
    v_lshrrev_b32 v2, 6, v0
    v_and_b32 v3, 15, v1
    v_lshrrev_b32 v4, 4, v1
    s_nop 0
    v_readfirstlane_b32 s36, v2
    s_waitcnt lgkmcnt(0)
    v_lshlrev_b32 v5, 16, v4
    v_lshl_add_u32 v5, v3, 1, v5
    s_lshl_b32 s37, s34, 8
    s_lshl_b32 s38, s35, 6
    s_add_u32 s37, s37, s38
    s_lshl_b32 s38, s36, 20
    s_add_u32 s37, s37, s38
    s_add_u32 s39, s37, 0
    buffer_load_ushort v192, v5, s[12:15], s39 offen offset:0
    s_add_u32 s60, s39, 8192
    buffer_load_ushort v193, v5, s[12:15], s60 offen
    s_add_u32 s60, s39, 16384
    buffer_load_ushort v194, v5, s[12:15], s60 offen
    s_add_u32 s60, s39, 24576
    buffer_load_ushort v195, v5, s[12:15], s60 offen
    s_add_u32 s60, s39, 32768
    buffer_load_ushort v196, v5, s[12:15], s60 offen
    s_add_u32 s60, s39, 40960
    buffer_load_ushort v197, v5, s[12:15], s60 offen
    s_add_u32 s60, s39, 49152
    buffer_load_ushort v198, v5, s[12:15], s60 offen
    s_add_u32 s60, s39, 57344
    buffer_load_ushort v199, v5, s[12:15], s60 offen
    s_add_u32 s39, s37, 262144
    buffer_load_ushort v200, v5, s[12:15], s39 offen offset:0
    s_add_u32 s60, s39, 8192
    buffer_load_ushort v201, v5, s[12:15], s60 offen
    s_add_u32 s60, s39, 16384
    buffer_load_ushort v202, v5, s[12:15], s60 offen
    s_add_u32 s60, s39, 24576
    buffer_load_ushort v203, v5, s[12:15], s60 offen
    s_add_u32 s60, s39, 32768
    buffer_load_ushort v204, v5, s[12:15], s60 offen
    s_add_u32 s60, s39, 40960
    buffer_load_ushort v205, v5, s[12:15], s60 offen
    s_add_u32 s60, s39, 49152
    buffer_load_ushort v206, v5, s[12:15], s60 offen
    s_add_u32 s60, s39, 57344
    buffer_load_ushort v207, v5, s[12:15], s60 offen
    s_add_u32 s39, s37, 524288
    buffer_load_ushort v208, v5, s[12:15], s39 offen offset:0
    s_add_u32 s60, s39, 8192
    buffer_load_ushort v209, v5, s[12:15], s60 offen
    s_add_u32 s60, s39, 16384
    buffer_load_ushort v210, v5, s[12:15], s60 offen
    s_add_u32 s60, s39, 24576
    buffer_load_ushort v211, v5, s[12:15], s60 offen
    s_add_u32 s60, s39, 32768
    buffer_load_ushort v212, v5, s[12:15], s60 offen
    s_add_u32 s60, s39, 40960
    buffer_load_ushort v213, v5, s[12:15], s60 offen
    s_add_u32 s60, s39, 49152
    buffer_load_ushort v214, v5, s[12:15], s60 offen
    s_add_u32 s60, s39, 57344
    buffer_load_ushort v215, v5, s[12:15], s60 offen
    s_add_u32 s39, s37, 786432
    buffer_load_ushort v216, v5, s[12:15], s39 offen offset:0
    s_add_u32 s60, s39, 8192
    buffer_load_ushort v217, v5, s[12:15], s60 offen
    s_add_u32 s60, s39, 16384
    buffer_load_ushort v218, v5, s[12:15], s60 offen
    s_add_u32 s60, s39, 24576
    buffer_load_ushort v219, v5, s[12:15], s60 offen
    s_add_u32 s60, s39, 32768
    buffer_load_ushort v220, v5, s[12:15], s60 offen
    s_add_u32 s60, s39, 40960
    buffer_load_ushort v221, v5, s[12:15], s60 offen
    s_add_u32 s60, s39, 49152
    buffer_load_ushort v222, v5, s[12:15], s60 offen
    s_add_u32 s60, s39, 57344
    buffer_load_ushort v223, v5, s[12:15], s60 offen
    s_waitcnt vmcnt(0)
    v_lshl_or_b32 v64, v193, 16, v192
    v_lshl_or_b32 v65, v195, 16, v194
    v_lshl_or_b32 v66, v197, 16, v196
    v_lshl_or_b32 v67, v199, 16, v198
    v_lshl_or_b32 v68, v201, 16, v200
    v_lshl_or_b32 v69, v203, 16, v202
    v_lshl_or_b32 v70, v205, 16, v204
    v_lshl_or_b32 v71, v207, 16, v206
    v_lshl_or_b32 v72, v209, 16, v208
    v_lshl_or_b32 v73, v211, 16, v210
    v_lshl_or_b32 v74, v213, 16, v212
    v_lshl_or_b32 v75, v215, 16, v214
    v_lshl_or_b32 v76, v217, 16, v216
    v_lshl_or_b32 v77, v219, 16, v218
    v_lshl_or_b32 v78, v221, 16, v220
    v_lshl_or_b32 v79, v223, 16, v222
    s_add_u32 s39, s37, 32
    buffer_load_ushort v192, v5, s[12:15], s39 offen offset:0
    s_add_u32 s60, s39, 8192
    buffer_load_ushort v193, v5, s[12:15], s60 offen
    s_add_u32 s60, s39, 16384
    buffer_load_ushort v194, v5, s[12:15], s60 offen
    s_add_u32 s60, s39, 24576
    buffer_load_ushort v195, v5, s[12:15], s60 offen
    s_add_u32 s60, s39, 32768
    buffer_load_ushort v196, v5, s[12:15], s60 offen
    s_add_u32 s60, s39, 40960
    buffer_load_ushort v197, v5, s[12:15], s60 offen
    s_add_u32 s60, s39, 49152
    buffer_load_ushort v198, v5, s[12:15], s60 offen
    s_add_u32 s60, s39, 57344
    buffer_load_ushort v199, v5, s[12:15], s60 offen
    s_add_u32 s39, s37, 262176
    buffer_load_ushort v200, v5, s[12:15], s39 offen offset:0
    s_add_u32 s60, s39, 8192
    buffer_load_ushort v201, v5, s[12:15], s60 offen
    s_add_u32 s60, s39, 16384
    buffer_load_ushort v202, v5, s[12:15], s60 offen
    s_add_u32 s60, s39, 24576
    buffer_load_ushort v203, v5, s[12:15], s60 offen
    s_add_u32 s60, s39, 32768
    buffer_load_ushort v204, v5, s[12:15], s60 offen
    s_add_u32 s60, s39, 40960
    buffer_load_ushort v205, v5, s[12:15], s60 offen
    s_add_u32 s60, s39, 49152
    buffer_load_ushort v206, v5, s[12:15], s60 offen
    s_add_u32 s60, s39, 57344
    buffer_load_ushort v207, v5, s[12:15], s60 offen
    s_add_u32 s39, s37, 524320
    buffer_load_ushort v208, v5, s[12:15], s39 offen offset:0
    s_add_u32 s60, s39, 8192
    buffer_load_ushort v209, v5, s[12:15], s60 offen
    s_add_u32 s60, s39, 16384
    buffer_load_ushort v210, v5, s[12:15], s60 offen
    s_add_u32 s60, s39, 24576
    buffer_load_ushort v211, v5, s[12:15], s60 offen
    s_add_u32 s60, s39, 32768
    buffer_load_ushort v212, v5, s[12:15], s60 offen
    s_add_u32 s60, s39, 40960
    buffer_load_ushort v213, v5, s[12:15], s60 offen
    s_add_u32 s60, s39, 49152
    buffer_load_ushort v214, v5, s[12:15], s60 offen
    s_add_u32 s60, s39, 57344
    buffer_load_ushort v215, v5, s[12:15], s60 offen
    s_add_u32 s39, s37, 786464
    buffer_load_ushort v216, v5, s[12:15], s39 offen offset:0
    s_add_u32 s60, s39, 8192
    buffer_load_ushort v217, v5, s[12:15], s60 offen
    s_add_u32 s60, s39, 16384
    buffer_load_ushort v218, v5, s[12:15], s60 offen
    s_add_u32 s60, s39, 24576
    buffer_load_ushort v219, v5, s[12:15], s60 offen
    s_add_u32 s60, s39, 32768
    buffer_load_ushort v220, v5, s[12:15], s60 offen
    s_add_u32 s60, s39, 40960
    buffer_load_ushort v221, v5, s[12:15], s60 offen
    s_add_u32 s60, s39, 49152
    buffer_load_ushort v222, v5, s[12:15], s60 offen
    s_add_u32 s60, s39, 57344
    buffer_load_ushort v223, v5, s[12:15], s60 offen
    s_waitcnt vmcnt(0)
    v_lshl_or_b32 v80, v193, 16, v192
    v_lshl_or_b32 v81, v195, 16, v194
    v_lshl_or_b32 v82, v197, 16, v196
    v_lshl_or_b32 v83, v199, 16, v198
    v_lshl_or_b32 v84, v201, 16, v200
    v_lshl_or_b32 v85, v203, 16, v202
    v_lshl_or_b32 v86, v205, 16, v204
    v_lshl_or_b32 v87, v207, 16, v206
    v_lshl_or_b32 v88, v209, 16, v208
    v_lshl_or_b32 v89, v211, 16, v210
    v_lshl_or_b32 v90, v213, 16, v212
    v_lshl_or_b32 v91, v215, 16, v214
    v_lshl_or_b32 v92, v217, 16, v216
    v_lshl_or_b32 v93, v219, 16, v218
    v_lshl_or_b32 v94, v221, 16, v220
    v_lshl_or_b32 v95, v223, 16, v222
    s_add_u32 s39, s37, 0
    buffer_load_ushort v192, v5, s[16:19], s39 offen offset:0
    s_add_u32 s60, s39, 8192
    buffer_load_ushort v193, v5, s[16:19], s60 offen
    s_add_u32 s60, s39, 16384
    buffer_load_ushort v194, v5, s[16:19], s60 offen
    s_add_u32 s60, s39, 24576
    buffer_load_ushort v195, v5, s[16:19], s60 offen
    s_add_u32 s60, s39, 32768
    buffer_load_ushort v196, v5, s[16:19], s60 offen
    s_add_u32 s60, s39, 40960
    buffer_load_ushort v197, v5, s[16:19], s60 offen
    s_add_u32 s60, s39, 49152
    buffer_load_ushort v198, v5, s[16:19], s60 offen
    s_add_u32 s60, s39, 57344
    buffer_load_ushort v199, v5, s[16:19], s60 offen
    s_add_u32 s39, s37, 262144
    buffer_load_ushort v200, v5, s[16:19], s39 offen offset:0
    s_add_u32 s60, s39, 8192
    buffer_load_ushort v201, v5, s[16:19], s60 offen
    s_add_u32 s60, s39, 16384
    buffer_load_ushort v202, v5, s[16:19], s60 offen
    s_add_u32 s60, s39, 24576
    buffer_load_ushort v203, v5, s[16:19], s60 offen
    s_add_u32 s60, s39, 32768
    buffer_load_ushort v204, v5, s[16:19], s60 offen
    s_add_u32 s60, s39, 40960
    buffer_load_ushort v205, v5, s[16:19], s60 offen
    s_add_u32 s60, s39, 49152
    buffer_load_ushort v206, v5, s[16:19], s60 offen
    s_add_u32 s60, s39, 57344
    buffer_load_ushort v207, v5, s[16:19], s60 offen
    s_add_u32 s39, s37, 524288
    buffer_load_ushort v208, v5, s[16:19], s39 offen offset:0
    s_add_u32 s60, s39, 8192
    buffer_load_ushort v209, v5, s[16:19], s60 offen
    s_add_u32 s60, s39, 16384
    buffer_load_ushort v210, v5, s[16:19], s60 offen
    s_add_u32 s60, s39, 24576
    buffer_load_ushort v211, v5, s[16:19], s60 offen
    s_add_u32 s60, s39, 32768
    buffer_load_ushort v212, v5, s[16:19], s60 offen
    s_add_u32 s60, s39, 40960
    buffer_load_ushort v213, v5, s[16:19], s60 offen
    s_add_u32 s60, s39, 49152
    buffer_load_ushort v214, v5, s[16:19], s60 offen
    s_add_u32 s60, s39, 57344
    buffer_load_ushort v215, v5, s[16:19], s60 offen
    s_add_u32 s39, s37, 786432
    buffer_load_ushort v216, v5, s[16:19], s39 offen offset:0
    s_add_u32 s60, s39, 8192
    buffer_load_ushort v217, v5, s[16:19], s60 offen
    s_add_u32 s60, s39, 16384
    buffer_load_ushort v218, v5, s[16:19], s60 offen
    s_add_u32 s60, s39, 24576
    buffer_load_ushort v219, v5, s[16:19], s60 offen
    s_add_u32 s60, s39, 32768
    buffer_load_ushort v220, v5, s[16:19], s60 offen
    s_add_u32 s60, s39, 40960
    buffer_load_ushort v221, v5, s[16:19], s60 offen
    s_add_u32 s60, s39, 49152
    buffer_load_ushort v222, v5, s[16:19], s60 offen
    s_add_u32 s60, s39, 57344
    buffer_load_ushort v223, v5, s[16:19], s60 offen
    s_waitcnt vmcnt(0)
    v_lshl_or_b32 v96, v193, 16, v192
    v_lshl_or_b32 v97, v195, 16, v194
    v_lshl_or_b32 v98, v197, 16, v196
    v_lshl_or_b32 v99, v199, 16, v198
    v_lshl_or_b32 v100, v201, 16, v200
    v_lshl_or_b32 v101, v203, 16, v202
    v_lshl_or_b32 v102, v205, 16, v204
    v_lshl_or_b32 v103, v207, 16, v206
    v_lshl_or_b32 v104, v209, 16, v208
    v_lshl_or_b32 v105, v211, 16, v210
    v_lshl_or_b32 v106, v213, 16, v212
    v_lshl_or_b32 v107, v215, 16, v214
    v_lshl_or_b32 v108, v217, 16, v216
    v_lshl_or_b32 v109, v219, 16, v218
    v_lshl_or_b32 v110, v221, 16, v220
    v_lshl_or_b32 v111, v223, 16, v222
    s_add_u32 s39, s37, 32
    buffer_load_ushort v192, v5, s[16:19], s39 offen offset:0
    s_add_u32 s60, s39, 8192
    buffer_load_ushort v193, v5, s[16:19], s60 offen
    s_add_u32 s60, s39, 16384
    buffer_load_ushort v194, v5, s[16:19], s60 offen
    s_add_u32 s60, s39, 24576
    buffer_load_ushort v195, v5, s[16:19], s60 offen
    s_add_u32 s60, s39, 32768
    buffer_load_ushort v196, v5, s[16:19], s60 offen
    s_add_u32 s60, s39, 40960
    buffer_load_ushort v197, v5, s[16:19], s60 offen
    s_add_u32 s60, s39, 49152
    buffer_load_ushort v198, v5, s[16:19], s60 offen
    s_add_u32 s60, s39, 57344
    buffer_load_ushort v199, v5, s[16:19], s60 offen
    s_add_u32 s39, s37, 262176
    buffer_load_ushort v200, v5, s[16:19], s39 offen offset:0
    s_add_u32 s60, s39, 8192
    buffer_load_ushort v201, v5, s[16:19], s60 offen
    s_add_u32 s60, s39, 16384
    buffer_load_ushort v202, v5, s[16:19], s60 offen
    s_add_u32 s60, s39, 24576
    buffer_load_ushort v203, v5, s[16:19], s60 offen
    s_add_u32 s60, s39, 32768
    buffer_load_ushort v204, v5, s[16:19], s60 offen
    s_add_u32 s60, s39, 40960
    buffer_load_ushort v205, v5, s[16:19], s60 offen
    s_add_u32 s60, s39, 49152
    buffer_load_ushort v206, v5, s[16:19], s60 offen
    s_add_u32 s60, s39, 57344
    buffer_load_ushort v207, v5, s[16:19], s60 offen
    s_add_u32 s39, s37, 524320
    buffer_load_ushort v208, v5, s[16:19], s39 offen offset:0
    s_add_u32 s60, s39, 8192
    buffer_load_ushort v209, v5, s[16:19], s60 offen
    s_add_u32 s60, s39, 16384
    buffer_load_ushort v210, v5, s[16:19], s60 offen
    s_add_u32 s60, s39, 24576
    buffer_load_ushort v211, v5, s[16:19], s60 offen
    s_add_u32 s60, s39, 32768
    buffer_load_ushort v212, v5, s[16:19], s60 offen
    s_add_u32 s60, s39, 40960
    buffer_load_ushort v213, v5, s[16:19], s60 offen
    s_add_u32 s60, s39, 49152
    buffer_load_ushort v214, v5, s[16:19], s60 offen
    s_add_u32 s60, s39, 57344
    buffer_load_ushort v215, v5, s[16:19], s60 offen
    s_add_u32 s39, s37, 786464
    buffer_load_ushort v216, v5, s[16:19], s39 offen offset:0
    s_add_u32 s60, s39, 8192
    buffer_load_ushort v217, v5, s[16:19], s60 offen
    s_add_u32 s60, s39, 16384
    buffer_load_ushort v218, v5, s[16:19], s60 offen
    s_add_u32 s60, s39, 24576
    buffer_load_ushort v219, v5, s[16:19], s60 offen
    s_add_u32 s60, s39, 32768
    buffer_load_ushort v220, v5, s[16:19], s60 offen
    s_add_u32 s60, s39, 40960
    buffer_load_ushort v221, v5, s[16:19], s60 offen
    s_add_u32 s60, s39, 49152
    buffer_load_ushort v222, v5, s[16:19], s60 offen
    s_add_u32 s60, s39, 57344
    buffer_load_ushort v223, v5, s[16:19], s60 offen
    s_waitcnt vmcnt(0)
    v_lshl_or_b32 v112, v193, 16, v192
    v_lshl_or_b32 v113, v195, 16, v194
    v_lshl_or_b32 v114, v197, 16, v196
    v_lshl_or_b32 v115, v199, 16, v198
    v_lshl_or_b32 v116, v201, 16, v200
    v_lshl_or_b32 v117, v203, 16, v202
    v_lshl_or_b32 v118, v205, 16, v204
    v_lshl_or_b32 v119, v207, 16, v206
    v_lshl_or_b32 v120, v209, 16, v208
    v_lshl_or_b32 v121, v211, 16, v210
    v_lshl_or_b32 v122, v213, 16, v212
    v_lshl_or_b32 v123, v215, 16, v214
    v_lshl_or_b32 v124, v217, 16, v216
    v_lshl_or_b32 v125, v219, 16, v218
    v_lshl_or_b32 v126, v221, 16, v220
    v_lshl_or_b32 v127, v223, 16, v222
    s_add_u32 s39, s37, 0
    buffer_load_ushort v192, v5, s[20:23], s39 offen offset:0
    s_add_u32 s60, s39, 8192
    buffer_load_ushort v193, v5, s[20:23], s60 offen
    s_add_u32 s60, s39, 16384
    buffer_load_ushort v194, v5, s[20:23], s60 offen
    s_add_u32 s60, s39, 24576
    buffer_load_ushort v195, v5, s[20:23], s60 offen
    s_add_u32 s60, s39, 32768
    buffer_load_ushort v196, v5, s[20:23], s60 offen
    s_add_u32 s60, s39, 40960
    buffer_load_ushort v197, v5, s[20:23], s60 offen
    s_add_u32 s60, s39, 49152
    buffer_load_ushort v198, v5, s[20:23], s60 offen
    s_add_u32 s60, s39, 57344
    buffer_load_ushort v199, v5, s[20:23], s60 offen
    s_add_u32 s39, s37, 262144
    buffer_load_ushort v200, v5, s[20:23], s39 offen offset:0
    s_add_u32 s60, s39, 8192
    buffer_load_ushort v201, v5, s[20:23], s60 offen
    s_add_u32 s60, s39, 16384
    buffer_load_ushort v202, v5, s[20:23], s60 offen
    s_add_u32 s60, s39, 24576
    buffer_load_ushort v203, v5, s[20:23], s60 offen
    s_add_u32 s60, s39, 32768
    buffer_load_ushort v204, v5, s[20:23], s60 offen
    s_add_u32 s60, s39, 40960
    buffer_load_ushort v205, v5, s[20:23], s60 offen
    s_add_u32 s60, s39, 49152
    buffer_load_ushort v206, v5, s[20:23], s60 offen
    s_add_u32 s60, s39, 57344
    buffer_load_ushort v207, v5, s[20:23], s60 offen
    s_add_u32 s39, s37, 524288
    buffer_load_ushort v208, v5, s[20:23], s39 offen offset:0
    s_add_u32 s60, s39, 8192
    buffer_load_ushort v209, v5, s[20:23], s60 offen
    s_add_u32 s60, s39, 16384
    buffer_load_ushort v210, v5, s[20:23], s60 offen
    s_add_u32 s60, s39, 24576
    buffer_load_ushort v211, v5, s[20:23], s60 offen
    s_add_u32 s60, s39, 32768
    buffer_load_ushort v212, v5, s[20:23], s60 offen
    s_add_u32 s60, s39, 40960
    buffer_load_ushort v213, v5, s[20:23], s60 offen
    s_add_u32 s60, s39, 49152
    buffer_load_ushort v214, v5, s[20:23], s60 offen
    s_add_u32 s60, s39, 57344
    buffer_load_ushort v215, v5, s[20:23], s60 offen
    s_add_u32 s39, s37, 786432
    buffer_load_ushort v216, v5, s[20:23], s39 offen offset:0
    s_add_u32 s60, s39, 8192
    buffer_load_ushort v217, v5, s[20:23], s60 offen
    s_add_u32 s60, s39, 16384
    buffer_load_ushort v218, v5, s[20:23], s60 offen
    s_add_u32 s60, s39, 24576
    buffer_load_ushort v219, v5, s[20:23], s60 offen
    s_add_u32 s60, s39, 32768
    buffer_load_ushort v220, v5, s[20:23], s60 offen
    s_add_u32 s60, s39, 40960
    buffer_load_ushort v221, v5, s[20:23], s60 offen
    s_add_u32 s60, s39, 49152
    buffer_load_ushort v222, v5, s[20:23], s60 offen
    s_add_u32 s60, s39, 57344
    buffer_load_ushort v223, v5, s[20:23], s60 offen
    s_waitcnt vmcnt(0)
    v_lshl_or_b32 v128, v193, 16, v192
    v_lshl_or_b32 v129, v195, 16, v194
    v_lshl_or_b32 v130, v197, 16, v196
    v_lshl_or_b32 v131, v199, 16, v198
    v_lshl_or_b32 v132, v201, 16, v200
    v_lshl_or_b32 v133, v203, 16, v202
    v_lshl_or_b32 v134, v205, 16, v204
    v_lshl_or_b32 v135, v207, 16, v206
    v_lshl_or_b32 v136, v209, 16, v208
    v_lshl_or_b32 v137, v211, 16, v210
    v_lshl_or_b32 v138, v213, 16, v212
    v_lshl_or_b32 v139, v215, 16, v214
    v_lshl_or_b32 v140, v217, 16, v216
    v_lshl_or_b32 v141, v219, 16, v218
    v_lshl_or_b32 v142, v221, 16, v220
    v_lshl_or_b32 v143, v223, 16, v222
    s_add_u32 s39, s37, 32
    buffer_load_ushort v192, v5, s[20:23], s39 offen offset:0
    s_add_u32 s60, s39, 8192
    buffer_load_ushort v193, v5, s[20:23], s60 offen
    s_add_u32 s60, s39, 16384
    buffer_load_ushort v194, v5, s[20:23], s60 offen
    s_add_u32 s60, s39, 24576
    buffer_load_ushort v195, v5, s[20:23], s60 offen
    s_add_u32 s60, s39, 32768
    buffer_load_ushort v196, v5, s[20:23], s60 offen
    s_add_u32 s60, s39, 40960
    buffer_load_ushort v197, v5, s[20:23], s60 offen
    s_add_u32 s60, s39, 49152
    buffer_load_ushort v198, v5, s[20:23], s60 offen
    s_add_u32 s60, s39, 57344
    buffer_load_ushort v199, v5, s[20:23], s60 offen
    s_add_u32 s39, s37, 262176
    buffer_load_ushort v200, v5, s[20:23], s39 offen offset:0
    s_add_u32 s60, s39, 8192
    buffer_load_ushort v201, v5, s[20:23], s60 offen
    s_add_u32 s60, s39, 16384
    buffer_load_ushort v202, v5, s[20:23], s60 offen
    s_add_u32 s60, s39, 24576
    buffer_load_ushort v203, v5, s[20:23], s60 offen
    s_add_u32 s60, s39, 32768
    buffer_load_ushort v204, v5, s[20:23], s60 offen
    s_add_u32 s60, s39, 40960
    buffer_load_ushort v205, v5, s[20:23], s60 offen
    s_add_u32 s60, s39, 49152
    buffer_load_ushort v206, v5, s[20:23], s60 offen
    s_add_u32 s60, s39, 57344
    buffer_load_ushort v207, v5, s[20:23], s60 offen
    s_add_u32 s39, s37, 524320
    buffer_load_ushort v208, v5, s[20:23], s39 offen offset:0
    s_add_u32 s60, s39, 8192
    buffer_load_ushort v209, v5, s[20:23], s60 offen
    s_add_u32 s60, s39, 16384
    buffer_load_ushort v210, v5, s[20:23], s60 offen
    s_add_u32 s60, s39, 24576
    buffer_load_ushort v211, v5, s[20:23], s60 offen
    s_add_u32 s60, s39, 32768
    buffer_load_ushort v212, v5, s[20:23], s60 offen
    s_add_u32 s60, s39, 40960
    buffer_load_ushort v213, v5, s[20:23], s60 offen
    s_add_u32 s60, s39, 49152
    buffer_load_ushort v214, v5, s[20:23], s60 offen
    s_add_u32 s60, s39, 57344
    buffer_load_ushort v215, v5, s[20:23], s60 offen
    s_add_u32 s39, s37, 786464
    buffer_load_ushort v216, v5, s[20:23], s39 offen offset:0
    s_add_u32 s60, s39, 8192
    buffer_load_ushort v217, v5, s[20:23], s60 offen
    s_add_u32 s60, s39, 16384
    buffer_load_ushort v218, v5, s[20:23], s60 offen
    s_add_u32 s60, s39, 24576
    buffer_load_ushort v219, v5, s[20:23], s60 offen
    s_add_u32 s60, s39, 32768
    buffer_load_ushort v220, v5, s[20:23], s60 offen
    s_add_u32 s60, s39, 40960
    buffer_load_ushort v221, v5, s[20:23], s60 offen
    s_add_u32 s60, s39, 49152
    buffer_load_ushort v222, v5, s[20:23], s60 offen
    s_add_u32 s60, s39, 57344
    buffer_load_ushort v223, v5, s[20:23], s60 offen
    s_waitcnt vmcnt(0)
    v_lshl_or_b32 v144, v193, 16, v192
    v_lshl_or_b32 v145, v195, 16, v194
    v_lshl_or_b32 v146, v197, 16, v196
    v_lshl_or_b32 v147, v199, 16, v198
    v_lshl_or_b32 v148, v201, 16, v200
    v_lshl_or_b32 v149, v203, 16, v202
    v_lshl_or_b32 v150, v205, 16, v204
    v_lshl_or_b32 v151, v207, 16, v206
    v_lshl_or_b32 v152, v209, 16, v208
    v_lshl_or_b32 v153, v211, 16, v210
    v_lshl_or_b32 v154, v213, 16, v212
    v_lshl_or_b32 v155, v215, 16, v214
    v_lshl_or_b32 v156, v217, 16, v216
    v_lshl_or_b32 v157, v219, 16, v218
    v_lshl_or_b32 v158, v221, 16, v220
    v_lshl_or_b32 v159, v223, 16, v222
    v_lshlrev_b32 v5, 14, v4
    v_lshl_add_u32 v5, v3, 1, v5
    s_lshl_b32 s37, s34, 18
    s_lshl_b32 s38, s35, 9
    s_add_u32 s37, s37, s38
    s_lshl_b32 s38, s36, 6
    s_add_u32 s37, s37, s38
    s_add_u32 s39, s37, 0
    buffer_load_ushort v192, v5, s[24:27], s39 offen offset:0
    buffer_load_ushort v193, v5, s[24:27], s39 offen offset:2048
    s_add_u32 s60, s39, 4096
    buffer_load_ushort v194, v5, s[24:27], s60 offen
    s_add_u32 s60, s39, 6144
    buffer_load_ushort v195, v5, s[24:27], s60 offen
    s_add_u32 s60, s39, 8192
    buffer_load_ushort v196, v5, s[24:27], s60 offen
    s_add_u32 s60, s39, 10240
    buffer_load_ushort v197, v5, s[24:27], s60 offen
    s_add_u32 s60, s39, 12288
    buffer_load_ushort v198, v5, s[24:27], s60 offen
    s_add_u32 s60, s39, 14336
    buffer_load_ushort v199, v5, s[24:27], s60 offen
    s_add_u32 s39, s37, 65536
    buffer_load_ushort v200, v5, s[24:27], s39 offen offset:0
    buffer_load_ushort v201, v5, s[24:27], s39 offen offset:2048
    s_add_u32 s60, s39, 4096
    buffer_load_ushort v202, v5, s[24:27], s60 offen
    s_add_u32 s60, s39, 6144
    buffer_load_ushort v203, v5, s[24:27], s60 offen
    s_add_u32 s60, s39, 8192
    buffer_load_ushort v204, v5, s[24:27], s60 offen
    s_add_u32 s60, s39, 10240
    buffer_load_ushort v205, v5, s[24:27], s60 offen
    s_add_u32 s60, s39, 12288
    buffer_load_ushort v206, v5, s[24:27], s60 offen
    s_add_u32 s60, s39, 14336
    buffer_load_ushort v207, v5, s[24:27], s60 offen
    s_add_u32 s39, s37, 131072
    buffer_load_ushort v208, v5, s[24:27], s39 offen offset:0
    buffer_load_ushort v209, v5, s[24:27], s39 offen offset:2048
    s_add_u32 s60, s39, 4096
    buffer_load_ushort v210, v5, s[24:27], s60 offen
    s_add_u32 s60, s39, 6144
    buffer_load_ushort v211, v5, s[24:27], s60 offen
    s_add_u32 s60, s39, 8192
    buffer_load_ushort v212, v5, s[24:27], s60 offen
    s_add_u32 s60, s39, 10240
    buffer_load_ushort v213, v5, s[24:27], s60 offen
    s_add_u32 s60, s39, 12288
    buffer_load_ushort v214, v5, s[24:27], s60 offen
    s_add_u32 s60, s39, 14336
    buffer_load_ushort v215, v5, s[24:27], s60 offen
    s_add_u32 s39, s37, 196608
    buffer_load_ushort v216, v5, s[24:27], s39 offen offset:0
    buffer_load_ushort v217, v5, s[24:27], s39 offen offset:2048
    s_add_u32 s60, s39, 4096
    buffer_load_ushort v218, v5, s[24:27], s60 offen
    s_add_u32 s60, s39, 6144
    buffer_load_ushort v219, v5, s[24:27], s60 offen
    s_add_u32 s60, s39, 8192
    buffer_load_ushort v220, v5, s[24:27], s60 offen
    s_add_u32 s60, s39, 10240
    buffer_load_ushort v221, v5, s[24:27], s60 offen
    s_add_u32 s60, s39, 12288
    buffer_load_ushort v222, v5, s[24:27], s60 offen
    s_add_u32 s60, s39, 14336
    buffer_load_ushort v223, v5, s[24:27], s60 offen
    s_waitcnt vmcnt(0)
    v_lshl_or_b32 v160, v193, 16, v192
    v_lshl_or_b32 v161, v195, 16, v194
    v_lshl_or_b32 v162, v197, 16, v196
    v_lshl_or_b32 v163, v199, 16, v198
    v_lshl_or_b32 v164, v201, 16, v200
    v_lshl_or_b32 v165, v203, 16, v202
    v_lshl_or_b32 v166, v205, 16, v204
    v_lshl_or_b32 v167, v207, 16, v206
    v_lshl_or_b32 v168, v209, 16, v208
    v_lshl_or_b32 v169, v211, 16, v210
    v_lshl_or_b32 v170, v213, 16, v212
    v_lshl_or_b32 v171, v215, 16, v214
    v_lshl_or_b32 v172, v217, 16, v216
    v_lshl_or_b32 v173, v219, 16, v218
    v_lshl_or_b32 v174, v221, 16, v220
    v_lshl_or_b32 v175, v223, 16, v222
    s_add_u32 s39, s37, 32
    buffer_load_ushort v192, v5, s[24:27], s39 offen offset:0
    buffer_load_ushort v193, v5, s[24:27], s39 offen offset:2048
    s_add_u32 s60, s39, 4096
    buffer_load_ushort v194, v5, s[24:27], s60 offen
    s_add_u32 s60, s39, 6144
    buffer_load_ushort v195, v5, s[24:27], s60 offen
    s_add_u32 s60, s39, 8192
    buffer_load_ushort v196, v5, s[24:27], s60 offen
    s_add_u32 s60, s39, 10240
    buffer_load_ushort v197, v5, s[24:27], s60 offen
    s_add_u32 s60, s39, 12288
    buffer_load_ushort v198, v5, s[24:27], s60 offen
    s_add_u32 s60, s39, 14336
    buffer_load_ushort v199, v5, s[24:27], s60 offen
    s_add_u32 s39, s37, 65568
    buffer_load_ushort v200, v5, s[24:27], s39 offen offset:0
    buffer_load_ushort v201, v5, s[24:27], s39 offen offset:2048
    s_add_u32 s60, s39, 4096
    buffer_load_ushort v202, v5, s[24:27], s60 offen
    s_add_u32 s60, s39, 6144
    buffer_load_ushort v203, v5, s[24:27], s60 offen
    s_add_u32 s60, s39, 8192
    buffer_load_ushort v204, v5, s[24:27], s60 offen
    s_add_u32 s60, s39, 10240
    buffer_load_ushort v205, v5, s[24:27], s60 offen
    s_add_u32 s60, s39, 12288
    buffer_load_ushort v206, v5, s[24:27], s60 offen
    s_add_u32 s60, s39, 14336
    buffer_load_ushort v207, v5, s[24:27], s60 offen
    s_add_u32 s39, s37, 131104
    buffer_load_ushort v208, v5, s[24:27], s39 offen offset:0
    buffer_load_ushort v209, v5, s[24:27], s39 offen offset:2048
    s_add_u32 s60, s39, 4096
    buffer_load_ushort v210, v5, s[24:27], s60 offen
    s_add_u32 s60, s39, 6144
    buffer_load_ushort v211, v5, s[24:27], s60 offen
    s_add_u32 s60, s39, 8192
    buffer_load_ushort v212, v5, s[24:27], s60 offen
    s_add_u32 s60, s39, 10240
    buffer_load_ushort v213, v5, s[24:27], s60 offen
    s_add_u32 s60, s39, 12288
    buffer_load_ushort v214, v5, s[24:27], s60 offen
    s_add_u32 s60, s39, 14336
    buffer_load_ushort v215, v5, s[24:27], s60 offen
    s_add_u32 s39, s37, 196640
    buffer_load_ushort v216, v5, s[24:27], s39 offen offset:0
    buffer_load_ushort v217, v5, s[24:27], s39 offen offset:2048
    s_add_u32 s60, s39, 4096
    buffer_load_ushort v218, v5, s[24:27], s60 offen
    s_add_u32 s60, s39, 6144
    buffer_load_ushort v219, v5, s[24:27], s60 offen
    s_add_u32 s60, s39, 8192
    buffer_load_ushort v220, v5, s[24:27], s60 offen
    s_add_u32 s60, s39, 10240
    buffer_load_ushort v221, v5, s[24:27], s60 offen
    s_add_u32 s60, s39, 12288
    buffer_load_ushort v222, v5, s[24:27], s60 offen
    s_add_u32 s60, s39, 14336
    buffer_load_ushort v223, v5, s[24:27], s60 offen
    s_waitcnt vmcnt(0)
    v_lshl_or_b32 v176, v193, 16, v192
    v_lshl_or_b32 v177, v195, 16, v194
    v_lshl_or_b32 v178, v197, 16, v196
    v_lshl_or_b32 v179, v199, 16, v198
    v_lshl_or_b32 v180, v201, 16, v200
    v_lshl_or_b32 v181, v203, 16, v202
    v_lshl_or_b32 v182, v205, 16, v204
    v_lshl_or_b32 v183, v207, 16, v206
    v_lshl_or_b32 v184, v209, 16, v208
    v_lshl_or_b32 v185, v211, 16, v210
    v_lshl_or_b32 v186, v213, 16, v212
    v_lshl_or_b32 v187, v215, 16, v214
    v_lshl_or_b32 v188, v217, 16, v216
    v_lshl_or_b32 v189, v219, 16, v218
    v_lshl_or_b32 v190, v221, 16, v220
    v_lshl_or_b32 v191, v223, 16, v222
    v_lshrrev_b32 v5, 3, v0
    v_and_b32 v6, 7, v0
    v_mul_u32_u24 v7, 272, v5
    v_lshl_add_u32 v7, v6, 5, v7
    v_mul_u32_u24 v8, 288, v5
    v_lshl_add_u32 v8, v6, 5, v8
    v_mov_b32 v192, 0
    v_mov_b32 v193, 0
    v_mov_b32 v194, 0
    v_mov_b32 v195, 0
    v_cmp_gt_u32 vcc, 64, v0
    s_and_saveexec_b64 s[40:41], vcc
    ds_write_b128 v7, v[192:195] offset:39808
    ds_write_b128 v8, v[192:195] offset:53504
    ds_write_b128 v7, v[192:195] offset:39824
    ds_write_b128 v8, v[192:195] offset:53520
    s_mov_b64 exec, s[40:41]
    v_lshrrev_b32 v5, 4, v0
    v_and_b32 v6, 15, v0
    v_mul_u32_u24 v9, 24576, v5
    v_lshl_add_u32 v9, v6, 4, v9
    v_mul_u32_u24 v10, 272, v5
    v_lshl_add_u32 v10, v6, 4, v10
    v_mul_u32_u24 v11, 288, v5
    v_lshl_add_u32 v11, v6, 4, v11
    v_and_b32 v5, 7, v3
    v_lshlrev_b32 v12, 12, v5
    v_lshl_add_u32 v12, v4, 5, v12
    s_lshl_b32 s38, s36, 9
    v_add_u32 v12, s38, v12
    v_lshrrev_b32 v13, 1, v12
    v_lshrrev_b32 v5, 3, v3
    v_lshl_add_u32 v255, v5, 8, v12
    v_lshlrev_b32 v14, 6, v3
    v_lshl_add_u32 v14, v4, 4, v14
    s_mul_i32 s38, s36, 3072
    v_add_u32 v14, s38, v14
    s_mov_b32 s38, 0x01555556
    v_add_u32 v5, 0, v0
    v_mul_hi_u32 v6, v5, s38
    v_mul_u32_u24 v7, 192, v6
    v_sub_u32 v7, v5, v7
    v_lshrrev_b32 v8, 3, v7
    v_and_b32 v7, 7, v7
    v_lshlrev_b32 v7, 3, v7
    v_lshl_add_u32 v7, v6, 6, v7
    v_and_b32 v6, 7, v8
    v_lshrrev_b32 v8, 3, v8
    v_mul_u32_u24 v15, 272, v6
    v_add_u32 v15, 24576, v15
    v_cmp_eq_u32 vcc, 1, v8
    v_mul_u32_u24 v5, 272, v6
    v_add_u32 v5, 28928, v5
    v_cndmask_b32 v15, v15, v5, vcc
    v_cmp_eq_u32 vcc, 2, v8
    v_mul_u32_u24 v5, 288, v6
    v_add_u32 v5, 41984, v5
    v_cndmask_b32 v15, v15, v5, vcc
    v_add_u32 v252, v15, v7
    v_add_u32 v5, 512, v0
    v_mul_hi_u32 v6, v5, s38
    v_mul_u32_u24 v7, 192, v6
    v_sub_u32 v7, v5, v7
    v_lshrrev_b32 v8, 3, v7
    v_and_b32 v7, 7, v7
    v_lshlrev_b32 v7, 3, v7
    v_lshl_add_u32 v7, v6, 6, v7
    v_and_b32 v6, 7, v8
    v_lshrrev_b32 v8, 3, v8
    v_mul_u32_u24 v15, 272, v6
    v_add_u32 v15, 24576, v15
    v_cmp_eq_u32 vcc, 1, v8
    v_mul_u32_u24 v5, 272, v6
    v_add_u32 v5, 28928, v5
    v_cndmask_b32 v15, v15, v5, vcc
    v_cmp_eq_u32 vcc, 2, v8
    v_mul_u32_u24 v5, 288, v6
    v_add_u32 v5, 41984, v5
    v_cndmask_b32 v15, v15, v5, vcc
    v_add_u32 v253, v15, v7
    v_lshrrev_b32 v5, 4, v0
    v_and_b32 v6, 15, v0
    v_lshrrev_b32 v7, 3, v5
    v_lshlrev_b32 v7, 1, v7
    v_lshrrev_b32 v8, 3, v6
    v_add_u32 v7, v7, v8
    v_lshlrev_b32 v254, 9, v7
    v_and_b32 v7, 7, v5
    v_lshl_add_u32 v254, v7, 6, v254
    v_and_b32 v7, 7, v6
    v_lshl_add_u32 v254, v7, 3, v254
    s_mul_i32 s42, s34, 12288
    s_add_u32 s42, s42, 103325696
    s_mul_i32 s43, s35, 3072
    s_add_u32 s43, s43, s42
    v_lshlrev_b32 v15, 4, v0
    s_mov_b32 s44, 0
    s_and_b32 s45, s44, 7
    s_cmp_lg_u32 s45, 0
    s_cbranch_scc1 tkx_2
    s_lshr_b32 s45, s44, 3
    s_lshl_b32 s45, s45, 7
    s_add_u32 s45, s45, 103719040
    s_mov_b32 s47, 4194304
    v_mov_b32 v8, 0
tkp_1:
    buffer_load_dword v48, v8, s[8:11], s45 offen sc1
    s_sub_u32 s47, s47, 1
    s_waitcnt vmcnt(0)
    s_cmp_eq_u32 s47, 0
    s_cbranch_scc1 tkx_2
    s_mov_b32 s46, 128
    v_cmp_ne_u32 vcc, s46, v48
    s_cbranch_vccnz tkp_1
tkx_2:
    s_mul_i32 s45, s44, 786432
    s_lshl_b32 s46, s34, 8
    s_add_u32 s45, s45, s46
    s_add_u32 s45, s45, 8396800
    s_add_u32 s46, s45, 8192
    buffer_load_dwordx4 v[48:51], v9, s[8:11], s45 offen sc1
    buffer_load_dwordx4 v[52:55], v9, s[8:11], s46 offen sc1
ch_step:
    s_waitcnt vmcnt(0)
    ds_write_b128 v10, v[48:51] offset:31104
    ds_write_b128 v11, v[52:55] offset:44288
    s_cmp_lg_u32 s44, 0
    s_cbranch_scc1 ch_poll
    buffer_load_dwordx4 v[16:19], v13, s[28:31], 0 offen offset:0
    buffer_load_dwordx4 v[20:23], v13, s[28:31], 0 offen offset:64
    buffer_load_dwordx4 v[24:27], v13, s[28:31], 0 offen offset:128
    buffer_load_dwordx4 v[28:31], v13, s[28:31], 0 offen offset:192
    s_waitcnt vmcnt(0)
    s_branch ch_qkv
ch_poll:
    s_cmp_lg_u32 s36, 0
    s_cbranch_scc1 ch_poll_x
    s_lshl_b32 s45, s44, 13
    s_add_u32 s45, s45, 102793216
    s_lshl_b32 s46, s32, 10
    s_add_u32 s45, s45, s46
    v_and_b32 v5, 3, v0
    v_lshlrev_b32 v5, 7, v5
    s_mov_b32 s47, 4194304
ch_poll_l:
    buffer_load_dword v6, v5, s[8:11], s45 offen sc1
    s_sub_u32 s47, s47, 1
    s_cmp_eq_u32 s47, 0
    s_cbranch_scc1 ch_poll_x
    s_waitcnt vmcnt(0)
    v_cmp_ne_u32 vcc, 32, v6
    s_cbranch_vccnz ch_poll_l
ch_poll_x:
    s_waitcnt vmcnt(0)
    s_barrier
    s_lshl_b32 s45, s44, 15
    s_add_u32 s45, s45, 100663296
    buffer_load_dwordx4 v[192:195], v255, s[8:11], s45 offen offset:0 sc1
    buffer_load_dwordx4 v[196:199], v255, s[8:11], s45 offen offset:16 sc1
    buffer_load_dwordx4 v[200:203], v255, s[8:11], s45 offen offset:128 sc1
    buffer_load_dwordx4 v[204:207], v255, s[8:11], s45 offen offset:144 sc1
    s_waitcnt vmcnt(2)
    v_cvt_pk_bf16_f32 v16, v192, v193
    v_cvt_pk_bf16_f32 v17, v194, v195
    v_cvt_pk_bf16_f32 v18, v196, v197
    v_cvt_pk_bf16_f32 v19, v198, v199
    s_waitcnt vmcnt(0)
    v_cvt_pk_bf16_f32 v20, v200, v201
    v_cvt_pk_bf16_f32 v21, v202, v203
    v_cvt_pk_bf16_f32 v22, v204, v205
    v_cvt_pk_bf16_f32 v23, v206, v207
    s_nop 1
    v_mov_b32_dpp v24, v16 row_ror:8 row_mask:0xf bank_mask:0xf
    v_mov_b32_dpp v25, v17 row_ror:8 row_mask:0xf bank_mask:0xf
    v_mov_b32_dpp v26, v18 row_ror:8 row_mask:0xf bank_mask:0xf
    v_mov_b32_dpp v27, v19 row_ror:8 row_mask:0xf bank_mask:0xf
    v_mov_b32_dpp v28, v20 row_ror:8 row_mask:0xf bank_mask:0xf
    v_mov_b32_dpp v29, v21 row_ror:8 row_mask:0xf bank_mask:0xf
    v_mov_b32_dpp v30, v22 row_ror:8 row_mask:0xf bank_mask:0xf
    v_mov_b32_dpp v31, v23 row_ror:8 row_mask:0xf bank_mask:0xf
ch_qkv:
    v_mov_b32 v224, 0
    v_mov_b32 v225, 0
    v_mov_b32 v226, 0
    v_mov_b32 v227, 0
    v_mov_b32 v228, 0
    v_mov_b32 v229, 0
    v_mov_b32 v230, 0
    v_mov_b32 v231, 0
    v_mov_b32 v232, 0
    v_mov_b32 v233, 0
    v_mov_b32 v234, 0
    v_mov_b32 v235, 0
    v_mov_b32 v236, 0
    v_mov_b32 v237, 0
    v_mov_b32 v238, 0
    v_mov_b32 v239, 0
    v_mov_b32 v240, 0
    v_mov_b32 v241, 0
    v_mov_b32 v242, 0
    v_mov_b32 v243, 0
    v_mov_b32 v244, 0
    v_mov_b32 v245, 0
    v_mov_b32 v246, 0
    v_mov_b32 v247, 0
    s_nop 1
    v_mfma_f32_16x16x32_bf16 v[224:227], v[64:67], v[16:19], v[224:227]
    v_mfma_f32_16x16x32_bf16 v[228:231], v[80:83], v[16:19], v[228:231]
    v_mfma_f32_16x16x32_bf16 v[232:235], v[96:99], v[16:19], v[232:235]
    v_mfma_f32_16x16x32_bf16 v[236:239], v[112:115], v[16:19], v[236:239]
    v_mfma_f32_16x16x32_bf16 v[240:243], v[128:131], v[16:19], v[240:243]
    v_mfma_f32_16x16x32_bf16 v[244:247], v[144:147], v[16:19], v[244:247]
    v_mfma_f32_16x16x32_bf16 v[224:227], v[68:71], v[20:23], v[224:227]
    v_mfma_f32_16x16x32_bf16 v[228:231], v[84:87], v[20:23], v[228:231]
    v_mfma_f32_16x16x32_bf16 v[232:235], v[100:103], v[20:23], v[232:235]
    v_mfma_f32_16x16x32_bf16 v[236:239], v[116:119], v[20:23], v[236:239]
    v_mfma_f32_16x16x32_bf16 v[240:243], v[132:135], v[20:23], v[240:243]
    v_mfma_f32_16x16x32_bf16 v[244:247], v[148:151], v[20:23], v[244:247]
    v_mfma_f32_16x16x32_bf16 v[224:227], v[72:75], v[24:27], v[224:227]
    v_mfma_f32_16x16x32_bf16 v[228:231], v[88:91], v[24:27], v[228:231]
    v_mfma_f32_16x16x32_bf16 v[232:235], v[104:107], v[24:27], v[232:235]
    v_mfma_f32_16x16x32_bf16 v[236:239], v[120:123], v[24:27], v[236:239]
    v_mfma_f32_16x16x32_bf16 v[240:243], v[136:139], v[24:27], v[240:243]
    v_mfma_f32_16x16x32_bf16 v[244:247], v[152:155], v[24:27], v[244:247]
    v_mfma_f32_16x16x32_bf16 v[224:227], v[76:79], v[28:31], v[224:227]
    v_mfma_f32_16x16x32_bf16 v[228:231], v[92:95], v[28:31], v[228:231]
    v_mfma_f32_16x16x32_bf16 v[232:235], v[108:111], v[28:31], v[232:235]
    v_mfma_f32_16x16x32_bf16 v[236:239], v[124:127], v[28:31], v[236:239]
    v_mfma_f32_16x16x32_bf16 v[240:243], v[140:143], v[28:31], v[240:243]
    v_mfma_f32_16x16x32_bf16 v[244:247], v[156:159], v[28:31], v[244:247]
    s_nop 7
    v_cmp_gt_u32 vcc, 8, v3
    s_and_saveexec_b64 s[40:41], vcc
    ds_write_b128 v14, v[224:227] offset:0
    ds_write_b128 v14, v[228:231] offset:512
    ds_write_b128 v14, v[232:235] offset:1024
    ds_write_b128 v14, v[236:239] offset:1536
    ds_write_b128 v14, v[240:243] offset:2048
    ds_write_b128 v14, v[244:247] offset:2560
    s_mov_b64 exec, s[40:41]
    s_waitcnt lgkmcnt(0)
    s_barrier
    v_cmp_gt_u32 vcc, 384, v0
    s_and_saveexec_b64 s[40:41], vcc
    s_cbranch_execz ch_pub_x
    ds_read_b64 v[192:193], v254 offset:0
    ds_read_b64 v[194:195], v254 offset:3072
    ds_read_b64 v[196:197], v254 offset:6144
    ds_read_b64 v[198:199], v254 offset:9216
    ds_read_b64 v[200:201], v254 offset:12288
    ds_read_b64 v[202:203], v254 offset:15360
    ds_read_b64 v[204:205], v254 offset:18432
    ds_read_b64 v[206:207], v254 offset:21504
    v_lshlrev_b32 v5, 3, v0
    s_add_u32 s45, s44, 1
    s_waitcnt lgkmcnt(0)
    v_pk_add_f32 v[192:193], v[192:193], v[194:195]
    v_pk_add_f32 v[196:197], v[196:197], v[198:199]
    v_pk_add_f32 v[200:201], v[200:201], v[202:203]
    v_pk_add_f32 v[204:205], v[204:205], v[206:207]
    v_pk_add_f32 v[192:193], v[192:193], v[196:197]
    v_pk_add_f32 v[200:201], v[200:201], v[204:205]
    v_pk_add_f32 v[192:193], v[192:193], v[200:201]
    v_cvt_pk_bf16_f32 v192, v192, v193
    v_mov_b32 v193, s45
    buffer_store_dwordx2 v[192:193], v5, s[8:11], s43 offen sc1
    v_cmp_le_u32 vcc, 128, v0
    s_and_b64 exec, exec, vcc
    v_lshrrev_b32 v6, 4, v0
    v_and_b32 v7, 15, v0
    v_subrev_u32 v6, 8, v6
    v_lshlrev_b32 v6, 8, v6
    v_lshl_add_u32 v6, v7, 2, v6
    s_lshl_b32 s45, s44, 5
    s_add_u32 s45, s45, s34
    s_lshl_b32 s45, s45, 12
    s_lshl_b32 s46, s35, 6
    s_add_u32 s45, s45, s46
    s_add_u32 s45, s45, 92274688
    buffer_store_dword v192, v6, s[8:11], s45 offen
ch_pub_x:
    s_mov_b64 exec, s[40:41]
    s_add_u32 s45, s44, 1
    s_mov_b32 s47, 4194304
    v_and_b32 v6, 255, v0
    v_lshlrev_b32 v6, 4, v6
    s_add_u32 s46, s42, 8192
ch_gat_l:
    buffer_load_dwordx4 v[200:203], v15, s[8:11], s42 offen sc1
    buffer_load_dwordx4 v[204:207], v6, s[8:11], s46 offen sc1
    s_sub_u32 s47, s47, 1
    s_waitcnt vmcnt(0)
    s_cmp_eq_u32 s47, 0
    s_cbranch_scc1 ch_gat_x
    v_xor_b32 v5, s45, v201
    v_xor_b32 v7, s45, v203
    v_or_b32 v5, v5, v7
    v_xor_b32 v7, s45, v205
    v_or_b32 v5, v5, v7
    v_xor_b32 v7, s45, v207
    v_or_b32 v5, v5, v7
    v_cmp_ne_u32 vcc, 0, v5
    s_cbranch_vccnz ch_gat_l
ch_gat_x:
    v_mov_b32 v201, v202
    v_mov_b32 v205, v206
    ds_write_b64 v252, v[200:201]
    v_cmp_gt_u32 vcc, 256, v0
    s_and_saveexec_b64 s[40:41], vcc
    ds_write_b64 v253, v[204:205]
    s_mov_b64 exec, s[40:41]
    s_waitcnt lgkmcnt(0)
    s_barrier
    v_mul_u32_u24 v5, 272, v3
    v_lshl_add_u32 v5, v4, 4, v5
    s_cmp_ge_u32 s36, 4
    s_cbranch_scc1 ch_att_x
    ds_read_b128 v[192:195], v5 offset:24576
    ds_read_b128 v[196:199], v5 offset:24640
    ds_read_b128 v[200:203], v5 offset:24704
    ds_read_b128 v[204:207], v5 offset:24768
    ds_read_b128 v[208:211], v5 offset:28928
    ds_read_b128 v[212:215], v5 offset:28992
    ds_read_b128 v[216:219], v5 offset:29056
    ds_read_b128 v[220:223], v5 offset:29120
    ds_read_b128 v[224:227], v5 offset:33280
    ds_read_b128 v[228:231], v5 offset:33344
    ds_read_b128 v[232:235], v5 offset:33408
    ds_read_b128 v[236:239], v5 offset:33472
    ds_read_b128 v[16:19], v5 offset:37632
    ds_read_b128 v[20:23], v5 offset:37696
    ds_read_b128 v[24:27], v5 offset:37760
    ds_read_b128 v[28:31], v5 offset:37824
    v_mov_b32 v32, 0
    v_mov_b32 v33, 0
    v_mov_b32 v34, 0
    v_mov_b32 v35, 0
    v_mov_b32 v36, 0
    v_mov_b32 v37, 0
    v_mov_b32 v38, 0
    v_mov_b32 v39, 0
    v_mov_b32 v40, 0
    v_mov_b32 v41, 0
    v_mov_b32 v42, 0
    v_mov_b32 v43, 0
    v_lshrrev_b32 v6, 2, v3
    v_lshl_add_u32 v6, v4, 2, v6
    v_mul_u32_u24 v6, 288, v6
    v_and_b32 v7, 3, v3
    v_lshl_add_u32 v6, v7, 3, v6
    s_lshl_b32 s46, s36, 6
    v_add_u32 v6, s46, v6
    s_waitcnt lgkmcnt(0)
    v_mfma_f32_16x16x32_bf16 v[32:35], v[208:211], v[192:195], v[32:35]
    v_mfma_f32_16x16x32_bf16 v[36:39], v[224:227], v[192:195], v[36:39]
    v_mfma_f32_16x16x32_bf16 v[40:43], v[16:19], v[192:195], v[40:43]
    v_mfma_f32_16x16x32_bf16 v[32:35], v[212:215], v[196:199], v[32:35]
    v_mfma_f32_16x16x32_bf16 v[36:39], v[228:231], v[196:199], v[36:39]
    v_mfma_f32_16x16x32_bf16 v[40:43], v[20:23], v[196:199], v[40:43]
    v_mfma_f32_16x16x32_bf16 v[32:35], v[216:219], v[200:203], v[32:35]
    v_mfma_f32_16x16x32_bf16 v[36:39], v[232:235], v[200:203], v[36:39]
    v_mfma_f32_16x16x32_bf16 v[40:43], v[24:27], v[200:203], v[40:43]
    v_mfma_f32_16x16x32_bf16 v[32:35], v[220:223], v[204:207], v[32:35]
    v_mfma_f32_16x16x32_bf16 v[36:39], v[236:239], v[204:207], v[36:39]
    v_mfma_f32_16x16x32_bf16 v[40:43], v[28:31], v[204:207], v[40:43]
    ds_read_b64_tr_b16 v[48:49], v6 offset:41984
    ds_read_b64_tr_b16 v[50:51], v6 offset:46592
    ds_read_b64_tr_b16 v[240:241], v6 offset:51200
    v_mov_b32 v242, 0
    v_mov_b32 v243, 0
    ds_read_b64_tr_b16 v[54:55], v6 offset:42016
    ds_read_b64_tr_b16 v[56:57], v6 offset:46624
    ds_read_b64_tr_b16 v[244:245], v6 offset:51232
    v_mov_b32 v246, 0
    v_mov_b32 v247, 0
    s_mov_b32 s46, 0x3db504f3
    s_mov_b32 s47, 0x3db504f3
    s_nop 4
    v_cvt_pk_bf16_f32 v192, v32, v33
    v_lshlrev_b32 v32, 16, v192
    v_and_b32 v33, 0xffff0000, v192
    v_pk_mul_f32 v[32:33], v[32:33], s[46:47]
    v_cvt_pk_bf16_f32 v192, v32, v33
    v_lshlrev_b32 v32, 16, v192
    v_and_b32 v33, 0xffff0000, v192
    v_cvt_pk_bf16_f32 v192, v34, v35
    v_lshlrev_b32 v34, 16, v192
    v_and_b32 v35, 0xffff0000, v192
    v_pk_mul_f32 v[34:35], v[34:35], s[46:47]
    v_cvt_pk_bf16_f32 v192, v34, v35
    v_lshlrev_b32 v34, 16, v192
    v_and_b32 v35, 0xffff0000, v192
    v_cvt_pk_bf16_f32 v192, v36, v37
    v_lshlrev_b32 v36, 16, v192
    v_and_b32 v37, 0xffff0000, v192
    v_pk_mul_f32 v[36:37], v[36:37], s[46:47]
    v_cvt_pk_bf16_f32 v192, v36, v37
    v_lshlrev_b32 v36, 16, v192
    v_and_b32 v37, 0xffff0000, v192
    v_cvt_pk_bf16_f32 v192, v38, v39
    v_lshlrev_b32 v38, 16, v192
    v_and_b32 v39, 0xffff0000, v192
    v_pk_mul_f32 v[38:39], v[38:39], s[46:47]
    v_cvt_pk_bf16_f32 v192, v38, v39
    v_lshlrev_b32 v38, 16, v192
    v_and_b32 v39, 0xffff0000, v192
    v_cvt_pk_bf16_f32 v192, v40, v41
    v_lshlrev_b32 v40, 16, v192
    v_and_b32 v41, 0xffff0000, v192
    v_pk_mul_f32 v[40:41], v[40:41], s[46:47]
    v_cvt_pk_bf16_f32 v192, v40, v41
    v_lshlrev_b32 v40, 16, v192
    v_and_b32 v41, 0xffff0000, v192
    v_cvt_pk_bf16_f32 v192, v42, v43
    v_lshlrev_b32 v42, 16, v192
    v_and_b32 v43, 0xffff0000, v192
    v_pk_mul_f32 v[42:43], v[42:43], s[46:47]
    v_cvt_pk_bf16_f32 v192, v42, v43
    v_lshlrev_b32 v42, 16, v192
    v_and_b32 v43, 0xffff0000, v192
    v_cmp_le_u32 vcc, 2, v4
    s_mov_b32 s46, 0xce6e6b28
    v_mov_b32 v192, s46
    v_cndmask_b32 v40, v40, v192, vcc
    v_cndmask_b32 v41, v41, v192, vcc
    v_cndmask_b32 v42, v42, v192, vcc
    v_cndmask_b32 v43, v43, v192, vcc
    v_max3_f32 v193, v32, v33, v34
    v_max3_f32 v193, v193, v35, v36
    v_max3_f32 v193, v193, v37, v38
    v_max3_f32 v193, v193, v39, v40
    v_max3_f32 v193, v193, v41, v42
    v_max_f32 v193, v193, v43
    v_mov_b32 v194, v193
    v_mov_b32 v195, v193
    s_nop 1
    v_permlane16_swap_b32 v194, v195
    v_max_f32 v193, v194, v195
    v_mov_b32 v194, v193
    v_mov_b32 v195, v193
    s_nop 1
    v_permlane32_swap_b32 v194, v195
    v_max_f32 v193, v194, v195
    s_mov_b32 s46, 0x3fb8aa3b
    v_sub_f32 v32, v32, v193
    v_mul_f32 v32, s46, v32
    v_exp_f32 v32, v32
    v_sub_f32 v33, v33, v193
    v_mul_f32 v33, s46, v33
    v_exp_f32 v33, v33
    v_sub_f32 v34, v34, v193
    v_mul_f32 v34, s46, v34
    v_exp_f32 v34, v34
    v_sub_f32 v35, v35, v193
    v_mul_f32 v35, s46, v35
    v_exp_f32 v35, v35
    v_sub_f32 v36, v36, v193
    v_mul_f32 v36, s46, v36
    v_exp_f32 v36, v36
    v_sub_f32 v37, v37, v193
    v_mul_f32 v37, s46, v37
    v_exp_f32 v37, v37
    v_sub_f32 v38, v38, v193
    v_mul_f32 v38, s46, v38
    v_exp_f32 v38, v38
    v_sub_f32 v39, v39, v193
    v_mul_f32 v39, s46, v39
    v_exp_f32 v39, v39
    v_sub_f32 v40, v40, v193
    v_mul_f32 v40, s46, v40
    v_exp_f32 v40, v40
    v_sub_f32 v41, v41, v193
    v_mul_f32 v41, s46, v41
    v_exp_f32 v41, v41
    v_sub_f32 v42, v42, v193
    v_mul_f32 v42, s46, v42
    v_exp_f32 v42, v42
    v_sub_f32 v43, v43, v193
    v_mul_f32 v43, s46, v43
    v_exp_f32 v43, v43
    s_nop 0
    v_add_f32 v193, v32, v33
    v_add_f32 v193, v193, v34
    v_add_f32 v193, v193, v35
    v_add_f32 v193, v193, v36
    v_add_f32 v193, v193, v37
    v_add_f32 v193, v193, v38
    v_add_f32 v193, v193, v39
    v_add_f32 v193, v193, v40
    v_add_f32 v193, v193, v41
    v_add_f32 v193, v193, v42
    v_add_f32 v193, v193, v43
    v_mov_b32 v194, v193
    v_mov_b32 v195, v193
    s_nop 1
    v_permlane16_swap_b32 v194, v195
    v_add_f32 v193, v194, v195
    v_mov_b32 v194, v193
    v_mov_b32 v195, v193
    s_nop 1
    v_permlane32_swap_b32 v194, v195
    v_add_f32 v193, v194, v195
    v_rcp_f32 v196, v193
    s_nop 0
    v_fma_f32 v197, -v193, v196, 1.0
    v_fma_f32 v196, v197, v196, v196
    v_mul_f32 v32, v32, v196
    v_mul_f32 v33, v33, v196
    v_cvt_pk_bf16_f32 v200, v32, v33
    v_mul_f32 v34, v34, v196
    v_mul_f32 v35, v35, v196
    v_cvt_pk_bf16_f32 v201, v34, v35
    v_mul_f32 v36, v36, v196
    v_mul_f32 v37, v37, v196
    v_cvt_pk_bf16_f32 v202, v36, v37
    v_mul_f32 v38, v38, v196
    v_mul_f32 v39, v39, v196
    v_cvt_pk_bf16_f32 v203, v38, v39
    v_mul_f32 v40, v40, v196
    v_mul_f32 v41, v41, v196
    v_cvt_pk_bf16_f32 v204, v40, v41
    v_mul_f32 v42, v42, v196
    v_mul_f32 v43, v43, v196
    v_cvt_pk_bf16_f32 v205, v42, v43
    v_mov_b32 v206, 0
    v_mov_b32 v207, 0
    v_mov_b32 v208, 0
    v_mov_b32 v209, 0
    v_mov_b32 v210, 0
    v_mov_b32 v211, 0
    v_mov_b32 v212, 0
    v_mov_b32 v213, 0
    v_mov_b32 v214, 0
    v_mov_b32 v215, 0
    s_waitcnt lgkmcnt(0)
    v_mfma_f32_16x16x32_bf16 v[208:211], v[48:51], v[200:203], v[208:211]
    v_mfma_f32_16x16x32_bf16 v[208:211], v[240:243], v[204:207], v[208:211]
    v_mfma_f32_16x16x32_bf16 v[212:215], v[54:57], v[200:203], v[212:215]
    v_mfma_f32_16x16x32_bf16 v[212:215], v[244:247], v[204:207], v[212:215]
    v_mul_u32_u24 v6, 272, v3
    v_lshl_add_u32 v6, v4, 3, v6
    s_lshl_b32 s46, s36, 6
    v_add_u32 v6, s46, v6
    s_nop 4
    v_cvt_pk_bf16_f32 v208, v208, v209
    v_cvt_pk_bf16_f32 v209, v210, v211
    ds_write_b64 v6, v[208:209] offset:55808
    v_cvt_pk_bf16_f32 v212, v212, v213
    v_cvt_pk_bf16_f32 v213, v214, v215
    ds_write_b64 v6, v[212:213] offset:55840
    s_waitcnt lgkmcnt(0)
ch_att_x:
    s_barrier
    ds_read_b128 v[224:227], v5 offset:55808
    ds_read_b128 v[228:231], v5 offset:55872
    ds_read_b128 v[232:235], v5 offset:55936
    ds_read_b128 v[236:239], v5 offset:56000
    v_mov_b32 v208, 0
    v_mov_b32 v209, 0
    v_mov_b32 v210, 0
    v_mov_b32 v211, 0
    v_mov_b32 v212, 0
    v_mov_b32 v213, 0
    v_mov_b32 v214, 0
    v_mov_b32 v215, 0
    s_waitcnt lgkmcnt(0)
    v_mfma_f32_16x16x32_bf16 v[208:211], v[224:227], v[160:163], v[208:211]
    v_mfma_f32_16x16x32_bf16 v[212:215], v[224:227], v[176:179], v[212:215]
    v_mfma_f32_16x16x32_bf16 v[208:211], v[228:231], v[164:167], v[208:211]
    v_mfma_f32_16x16x32_bf16 v[212:215], v[228:231], v[180:183], v[212:215]
    v_mfma_f32_16x16x32_bf16 v[208:211], v[232:235], v[168:171], v[208:211]
    v_mfma_f32_16x16x32_bf16 v[212:215], v[232:235], v[184:187], v[212:215]
    v_mfma_f32_16x16x32_bf16 v[208:211], v[236:239], v[172:175], v[208:211]
    v_mfma_f32_16x16x32_bf16 v[212:215], v[236:239], v[188:191], v[212:215]
    s_add_u32 s44, s44, 1
    v_lshlrev_b32 v6, 14, v4
    v_lshl_add_u32 v6, v3, 2, v6
    s_lshl_b32 s45, s44, 15
    s_add_u32 s45, s45, 100663296
    s_lshl_b32 s46, s35, 10
    s_add_u32 s45, s45, s46
    s_lshl_b32 s46, s36, 7
    s_add_u32 s45, s45, s46
    v_cmp_gt_u32 vcc, 32, v1
    s_nop 2
    s_and_saveexec_b64 s[40:41], vcc
    buffer_atomic_add_f32 v208, v6, s[8:11], s45 offen offset:0
    buffer_atomic_add_f32 v212, v6, s[8:11], s45 offen offset:64
    v_add_u32 v6, 4096, v6
    buffer_atomic_add_f32 v209, v6, s[8:11], s45 offen offset:0
    buffer_atomic_add_f32 v213, v6, s[8:11], s45 offen offset:64
    v_add_u32 v6, 4096, v6
    buffer_atomic_add_f32 v210, v6, s[8:11], s45 offen offset:0
    buffer_atomic_add_f32 v214, v6, s[8:11], s45 offen offset:64
    v_add_u32 v6, 4096, v6
    buffer_atomic_add_f32 v211, v6, s[8:11], s45 offen offset:0
    buffer_atomic_add_f32 v215, v6, s[8:11], s45 offen offset:64
    s_mov_b64 exec, s[40:41]
    s_waitcnt vmcnt(0)
    s_barrier
    v_cmp_gt_u32 vcc, 8, v0
    s_and_saveexec_b64 s[40:41], vcc
    s_lshl_b32 s45, s44, 13
    s_add_u32 s45, s45, 102793216
    s_lshl_b32 s46, s35, 7
    s_add_u32 s45, s45, s46
    v_mov_b32 v6, 1
    v_lshlrev_b32 v7, 10, v0
    buffer_atomic_add v6, v7, s[8:11], s45 offen
    s_mov_b64 exec, s[40:41]
    s_cmp_ge_u32 s44, 64
    s_cbranch_scc1 ch_end
    s_and_b32 s45, s44, 7
    s_cmp_lg_u32 s45, 0
    s_cbranch_scc1 tkx_4
    s_lshr_b32 s45, s44, 3
    s_lshl_b32 s45, s45, 7
    s_add_u32 s45, s45, 103719040
    s_mov_b32 s47, 4194304
    v_mov_b32 v8, 0
tkp_3:
    buffer_load_dword v48, v8, s[8:11], s45 offen sc1
    s_sub_u32 s47, s47, 1
    s_waitcnt vmcnt(0)
    s_cmp_eq_u32 s47, 0
    s_cbranch_scc1 tkx_4
    s_mov_b32 s46, 64
    v_cmp_ne_u32 vcc, s46, v48
    s_cbranch_vccnz tkp_3
tkx_4:
    s_mul_i32 s45, s44, 786432
    s_lshl_b32 s46, s34, 8
    s_add_u32 s45, s45, s46
    s_add_u32 s45, s45, 8396800
    s_add_u32 s46, s45, 8192
    buffer_load_dwordx4 v[48:51], v9, s[8:11], s45 offen sc1
    buffer_load_dwordx4 v[52:55], v9, s[8:11], s46 offen sc1
    s_branch ch_step
ch_end:
ch_done:
    s_endpgm
wk_entry:
    s_load_dwordx2 s[8:9], s[0:1], 112
    s_mov_b32 s10, 268435456
    s_mov_b32 s11, 0x00020000
    s_load_dwordx2 s[48:49], s[0:1], 16
    s_load_dwordx2 s[50:51], s[0:1], 24
    s_load_dwordx2 s[52:53], s[0:1], 32
    s_load_dwordx2 s[54:55], s[0:1], 64
    s_load_dwordx2 s[56:57], s[0:1], 80
    s_load_dwordx2 s[24:25], s[0:1], 72
    s_mov_b32 s26, 7168
    s_mov_b32 s27, 0x00020000
    s_load_dwordx2 s[64:65], s[0:1], 88
    s_mov_b32 s66, 2048
    s_mov_b32 s67, 0x00020000
    s_waitcnt lgkmcnt(0)
    s_mov_b32 s15, 0x00020000
wk_next:
    v_cmp_eq_u32 vcc, 0, v0
    s_and_saveexec_b64 s[40:41], vcc
    v_mov_b32 v1, 1
    v_mov_b32 v2, 0
    s_mov_b32 s33, 103718912
    buffer_atomic_add v1, v2, s[8:11], s33 offen sc0
    s_waitcnt vmcnt(0)
    v_mov_b32 v2, 118784
    ds_write_b32 v2, v1
    s_waitcnt lgkmcnt(0)
    s_mov_b64 exec, s[40:41]
    s_barrier
    v_mov_b32 v2, 118784
    ds_read_b32 v1, v2
    s_waitcnt lgkmcnt(0)
    v_readfirstlane_b32 s60, v1
    s_barrier
    s_cmp_ge_u32 s60, 1120
    s_cbranch_scc1 wk_done
    s_cmp_ge_u32 s60, 1056
    s_cbranch_scc1 wk_m2
    s_cmp_ge_u32 s60, 832
    s_cbranch_scc1 wk_m1
    s_cmp_lt_u32 s60, 128
    s_cbranch_scc1 wk_kv0
    s_sub_u32 s31, s60, 64
    s_lshr_b32 s30, s31, 6
    s_and_b32 s31, s31, 63
    s_add_u32 s31, s31, 32
    s_cmp_lt_u32 s60, 576
    s_cbranch_scc1 wk_qkv
    s_sub_u32 s31, s60, 576
    s_lshr_b32 s30, s31, 5
    s_and_b32 s31, s31, 31
wk_qkv:
    s_lshr_b32 s33, s31, 5
    s_mov_b32 s12, s48
    s_mov_b32 s13, s49
    s_cmp_eq_u32 s33, 1
    s_cselect_b32 s12, s50, s12
    s_cselect_b32 s13, s51, s13
    s_cmp_eq_u32 s33, 2
    s_cselect_b32 s12, s52, s12
    s_cselect_b32 s13, s53, s13
    s_mov_b32 s14, 8388608
    s_and_b32 s34, s31, 31
    s_lshl_b32 s34, s34, 8
    s_mov_b32 s35, 2048
    s_mov_b32 s36, 8192
    s_mov_b32 s37, 0
    s_mov_b32 s58, 8388608
    s_mov_b32 s59, 24576
    s_lshl_b32 s42, s31, 8
    s_mov_b32 s61, 8
    s_branch wk_go
wk_m1:
    s_sub_u32 s31, s60, 832
    s_mov_b32 s33, 0x0924924a
    s_mul_hi_u32 s30, s31, s33
    s_mul_i32 s33, s30, 28
    s_sub_u32 s31, s31, s33
    s_mov_b32 s12, s54
    s_mov_b32 s13, s55
    s_mov_b32 s14, 7340032
    s_lshl_b32 s34, s31, 8
    s_mov_b32 s35, 2048
    s_mov_b32 s36, 7168
    s_mov_b32 s37, 4194304
    s_mov_b32 s58, 58720256
    s_mov_b32 s59, 7168
    s_lshl_b32 s42, s31, 8
    s_mov_b32 s61, 8
    s_branch wk_go
wk_m2:
    s_sub_u32 s31, s60, 1056
    s_lshr_b32 s30, s31, 3
    s_and_b32 s31, s31, 7
    v_readfirstlane_b32 s33, v0
    s_cmp_lg_u32 s33, 0
    s_cbranch_scc1 wk_m2w
    s_lshl_b32 s33, s30, 7
    s_add_u32 s33, s33, 103721088
    v_mov_b32 v2, 0
    s_mov_b32 s47, 4194304
wk_m2p:
    buffer_load_dword v1, v2, s[8:11], s33 offen sc1
    s_sub_u32 s47, s47, 1
    s_waitcnt vmcnt(0)
    s_cmp_eq_u32 s47, 0
    s_cbranch_scc1 wk_m2w
    s_sleep 8
    v_cmp_ne_u32 vcc, 28, v1
    s_cbranch_vccnz wk_m2p
wk_m2w:
    s_barrier
    s_mov_b32 s12, s56
    s_mov_b32 s13, s57
    s_mov_b32 s14, 7340032
    s_lshl_b32 s34, s31, 8
    s_mov_b32 s35, 7168
    s_mov_b32 s36, 2048
    s_mov_b32 s37, 58720256
    s_mov_b32 s58, 109051904
    s_mov_b32 s59, 2048
    s_lshl_b32 s42, s31, 8
    s_mov_b32 s61, 28
wk_go:
    v_lshrrev_b32 v1, 3, v0
    v_and_b32 v2, 7, v0
    v_mul_u32_u24 v12, 160, v1
    v_lshl_add_u32 v12, v2, 4, v12
    v_lshrrev_b32 v1, 4, v0
    v_and_b32 v2, 15, v0
    v_mul_u32_u24 v13, 288, v1
    v_lshl_add_u32 v13, v2, 4, v13
    v_add_u32 v13, 40960, v13
    v_lshrrev_b32 v1, 6, v0
    v_and_b32 v2, 3, v1
    v_lshrrev_b32 v3, 2, v1
    v_and_b32 v16, 63, v0
    v_and_b32 v17, 15, v16
    v_lshrrev_b32 v18, 4, v16
    v_lshl_add_u32 v19, v2, 6, v17
    v_mul_u32_u24 v14, 160, v19
    v_lshl_add_u32 v14, v18, 4, v14
    v_lshrrev_b32 v19, 2, v17
    v_lshl_add_u32 v19, v18, 3, v19
    v_mul_u32_u24 v15, 288, v19
    v_and_b32 v19, 3, v17
    v_lshlrev_b32 v19, 2, v19
    v_lshl_add_u32 v19, v3, 6, v19
    v_lshl_add_u32 v15, v19, 1, v15
    v_add_u32 v15, 40960, v15
    v_add_u32 v224, 59392, v12
    v_add_u32 v225, 59392, v13
    v_add_u32 v226, 59392, v14
    v_add_u32 v227, 59392, v15
    s_lshl_b32 s32, s30, 8
    s_mov_b32 s38, 0
    s_lshl_b32 s39, s36, 6
    v_lshrrev_b32 v1, 3, v0
    v_and_b32 v2, 7, v0
    v_add_u32 v1, s32, v1
    v_add_u32 v3, 0, v1
    v_mul_lo_u32 v3, v3, s35
    v_lshl_add_u32 v4, v2, 4, v3
    v_add_u32 v3, 64, v1
    v_mul_lo_u32 v3, v3, s35
    v_lshl_add_u32 v5, v2, 4, v3
    v_add_u32 v3, 128, v1
    v_mul_lo_u32 v3, v3, s35
    v_lshl_add_u32 v6, v2, 4, v3
    v_add_u32 v3, 192, v1
    v_mul_lo_u32 v3, v3, s35
    v_lshl_add_u32 v7, v2, 4, v3
    v_lshrrev_b32 v1, 4, v0
    v_and_b32 v2, 15, v0
    v_add_u32 v3, 0, v1
    v_mul_lo_u32 v3, v3, s36
    v_lshl_add_u32 v3, v2, 4, v3
    v_add_u32 v8, s34, v3
    v_add_u32 v3, 32, v1
    v_mul_lo_u32 v3, v3, s36
    v_lshl_add_u32 v3, v2, 4, v3
    v_add_u32 v9, s34, v3
    v_mov_b32 v64, 0
    v_mov_b32 v65, 0
    v_mov_b32 v66, 0
    v_mov_b32 v67, 0
    v_mov_b32 v68, 0
    v_mov_b32 v69, 0
    v_mov_b32 v70, 0
    v_mov_b32 v71, 0
    v_mov_b32 v72, 0
    v_mov_b32 v73, 0
    v_mov_b32 v74, 0
    v_mov_b32 v75, 0
    v_mov_b32 v76, 0
    v_mov_b32 v77, 0
    v_mov_b32 v78, 0
    v_mov_b32 v79, 0
    v_mov_b32 v80, 0
    v_mov_b32 v81, 0
    v_mov_b32 v82, 0
    v_mov_b32 v83, 0
    v_mov_b32 v84, 0
    v_mov_b32 v85, 0
    v_mov_b32 v86, 0
    v_mov_b32 v87, 0
    v_mov_b32 v88, 0
    v_mov_b32 v89, 0
    v_mov_b32 v90, 0
    v_mov_b32 v91, 0
    v_mov_b32 v92, 0
    v_mov_b32 v93, 0
    v_mov_b32 v94, 0
    v_mov_b32 v95, 0
    v_mov_b32 v96, 0
    v_mov_b32 v97, 0
    v_mov_b32 v98, 0
    v_mov_b32 v99, 0
    v_mov_b32 v100, 0
    v_mov_b32 v101, 0
    v_mov_b32 v102, 0
    v_mov_b32 v103, 0
    v_mov_b32 v104, 0
    v_mov_b32 v105, 0
    v_mov_b32 v106, 0
    v_mov_b32 v107, 0
    v_mov_b32 v108, 0
    v_mov_b32 v109, 0
    v_mov_b32 v110, 0
    v_mov_b32 v111, 0
    v_mov_b32 v112, 0
    v_mov_b32 v113, 0
    v_mov_b32 v114, 0
    v_mov_b32 v115, 0
    v_mov_b32 v116, 0
    v_mov_b32 v117, 0
    v_mov_b32 v118, 0
    v_mov_b32 v119, 0
    v_mov_b32 v120, 0
    v_mov_b32 v121, 0
    v_mov_b32 v122, 0
    v_mov_b32 v123, 0
    v_mov_b32 v124, 0
    v_mov_b32 v125, 0
    v_mov_b32 v126, 0
    v_mov_b32 v127, 0
    buffer_load_dwordx4 v[128:131], v4, s[8:11], s37 offen sc1
    buffer_load_dwordx4 v[132:135], v5, s[8:11], s37 offen sc1
    buffer_load_dwordx4 v[136:139], v6, s[8:11], s37 offen sc1
    buffer_load_dwordx4 v[140:143], v7, s[8:11], s37 offen sc1
    buffer_load_dwordx4 v[144:147], v8, s[12:15], s38 offen
    buffer_load_dwordx4 v[148:151], v9, s[12:15], s38 offen
    s_add_u32 s37, s37, 128
    s_add_u32 s38, s38, s39
    buffer_load_dwordx4 v[228:231], v4, s[8:11], s37 offen sc1
    buffer_load_dwordx4 v[232:235], v5, s[8:11], s37 offen sc1
    buffer_load_dwordx4 v[236:239], v6, s[8:11], s37 offen sc1
    buffer_load_dwordx4 v[240:243], v7, s[8:11], s37 offen sc1
    buffer_load_dwordx4 v[244:247], v8, s[12:15], s38 offen
    buffer_load_dwordx4 v[248:251], v9, s[12:15], s38 offen
    s_waitcnt vmcnt(6)
    ds_write_b128 v12, v[128:131] offset:0
    ds_write_b128 v12, v[132:135] offset:10240
    ds_write_b128 v12, v[136:139] offset:20480
    ds_write_b128 v12, v[140:143] offset:30720
    ds_write_b128 v13, v[144:147] offset:0
    ds_write_b128 v13, v[148:151] offset:9216
    s_waitcnt lgkmcnt(0)
    s_barrier
    s_mov_b32 s43, s61
gk_5:
    s_cmp_eq_u32 s43, 1
    s_cbranch_scc1 gl_6a
    s_add_u32 s37, s37, 128
    s_add_u32 s38, s38, s39
    buffer_load_dwordx4 v[128:131], v4, s[8:11], s37 offen sc1
    buffer_load_dwordx4 v[132:135], v5, s[8:11], s37 offen sc1
    buffer_load_dwordx4 v[136:139], v6, s[8:11], s37 offen sc1
    buffer_load_dwordx4 v[140:143], v7, s[8:11], s37 offen sc1
    buffer_load_dwordx4 v[144:147], v8, s[12:15], s38 offen
    buffer_load_dwordx4 v[148:151], v9, s[12:15], s38 offen
gl_6a:
    ds_read_b64_tr_b16 v[160:161], v15 offset:0
    ds_read_b64_tr_b16 v[162:163], v15 offset:1152
    ds_read_b64_tr_b16 v[164:165], v15 offset:32
    ds_read_b64_tr_b16 v[166:167], v15 offset:1184
    ds_read_b64_tr_b16 v[168:169], v15 offset:64
    ds_read_b64_tr_b16 v[170:171], v15 offset:1216
    ds_read_b64_tr_b16 v[172:173], v15 offset:96
    ds_read_b64_tr_b16 v[174:175], v15 offset:1248
    ds_read_b128 v[192:195], v14 offset:0
    ds_read_b128 v[196:199], v14 offset:2560
    ds_read_b128 v[200:203], v14 offset:5120
    ds_read_b128 v[204:207], v14 offset:7680
    ds_read_b64_tr_b16 v[176:177], v15 offset:9216
    ds_read_b64_tr_b16 v[178:179], v15 offset:10368
    ds_read_b64_tr_b16 v[180:181], v15 offset:9248
    ds_read_b64_tr_b16 v[182:183], v15 offset:10400
    ds_read_b64_tr_b16 v[184:185], v15 offset:9280
    ds_read_b64_tr_b16 v[186:187], v15 offset:10432
    ds_read_b64_tr_b16 v[188:189], v15 offset:9312
    ds_read_b64_tr_b16 v[190:191], v15 offset:10464
    ds_read_b128 v[208:211], v14 offset:64
    ds_read_b128 v[212:215], v14 offset:2624
    ds_read_b128 v[216:219], v14 offset:5184
    ds_read_b128 v[220:223], v14 offset:7744
    s_waitcnt lgkmcnt(12)
    v_mfma_f32_16x16x32_bf16 v[64:67], v[160:163], v[192:195], v[64:67]
    v_mfma_f32_16x16x32_bf16 v[68:71], v[160:163], v[196:199], v[68:71]
    v_mfma_f32_16x16x32_bf16 v[72:75], v[160:163], v[200:203], v[72:75]
    v_mfma_f32_16x16x32_bf16 v[76:79], v[160:163], v[204:207], v[76:79]
    v_mfma_f32_16x16x32_bf16 v[80:83], v[164:167], v[192:195], v[80:83]
    v_mfma_f32_16x16x32_bf16 v[84:87], v[164:167], v[196:199], v[84:87]
    v_mfma_f32_16x16x32_bf16 v[88:91], v[164:167], v[200:203], v[88:91]
    v_mfma_f32_16x16x32_bf16 v[92:95], v[164:167], v[204:207], v[92:95]
    v_mfma_f32_16x16x32_bf16 v[96:99], v[168:171], v[192:195], v[96:99]
    v_mfma_f32_16x16x32_bf16 v[100:103], v[168:171], v[196:199], v[100:103]
    v_mfma_f32_16x16x32_bf16 v[104:107], v[168:171], v[200:203], v[104:107]
    v_mfma_f32_16x16x32_bf16 v[108:111], v[168:171], v[204:207], v[108:111]
    v_mfma_f32_16x16x32_bf16 v[112:115], v[172:175], v[192:195], v[112:115]
    v_mfma_f32_16x16x32_bf16 v[116:119], v[172:175], v[196:199], v[116:119]
    v_mfma_f32_16x16x32_bf16 v[120:123], v[172:175], v[200:203], v[120:123]
    v_mfma_f32_16x16x32_bf16 v[124:127], v[172:175], v[204:207], v[124:127]
    s_waitcnt lgkmcnt(0)
    v_mfma_f32_16x16x32_bf16 v[64:67], v[176:179], v[208:211], v[64:67]
    v_mfma_f32_16x16x32_bf16 v[68:71], v[176:179], v[212:215], v[68:71]
    v_mfma_f32_16x16x32_bf16 v[72:75], v[176:179], v[216:219], v[72:75]
    v_mfma_f32_16x16x32_bf16 v[76:79], v[176:179], v[220:223], v[76:79]
    v_mfma_f32_16x16x32_bf16 v[80:83], v[180:183], v[208:211], v[80:83]
    v_mfma_f32_16x16x32_bf16 v[84:87], v[180:183], v[212:215], v[84:87]
    v_mfma_f32_16x16x32_bf16 v[88:91], v[180:183], v[216:219], v[88:91]
    v_mfma_f32_16x16x32_bf16 v[92:95], v[180:183], v[220:223], v[92:95]
    v_mfma_f32_16x16x32_bf16 v[96:99], v[184:187], v[208:211], v[96:99]
    v_mfma_f32_16x16x32_bf16 v[100:103], v[184:187], v[212:215], v[100:103]
    v_mfma_f32_16x16x32_bf16 v[104:107], v[184:187], v[216:219], v[104:107]
    v_mfma_f32_16x16x32_bf16 v[108:111], v[184:187], v[220:223], v[108:111]
    v_mfma_f32_16x16x32_bf16 v[112:115], v[188:191], v[208:211], v[112:115]
    v_mfma_f32_16x16x32_bf16 v[116:119], v[188:191], v[212:215], v[116:119]
    v_mfma_f32_16x16x32_bf16 v[120:123], v[188:191], v[216:219], v[120:123]
    v_mfma_f32_16x16x32_bf16 v[124:127], v[188:191], v[220:223], v[124:127]
    s_cmp_eq_u32 s43, 1
    s_cbranch_scc1 gl_6b
    s_waitcnt vmcnt(6)
    ds_write_b128 v224, v[228:231] offset:0
    ds_write_b128 v224, v[232:235] offset:10240
    ds_write_b128 v224, v[236:239] offset:20480
    ds_write_b128 v224, v[240:243] offset:30720
    ds_write_b128 v225, v[244:247] offset:0
    ds_write_b128 v225, v[248:251] offset:9216
    s_waitcnt lgkmcnt(0)
    s_branch gl_6c
gl_6b:
    s_waitcnt vmcnt(0)
    ds_write_b128 v224, v[228:231] offset:0
    ds_write_b128 v224, v[232:235] offset:10240
    ds_write_b128 v224, v[236:239] offset:20480
    ds_write_b128 v224, v[240:243] offset:30720
    ds_write_b128 v225, v[244:247] offset:0
    ds_write_b128 v225, v[248:251] offset:9216
    s_waitcnt lgkmcnt(0)
gl_6c:
    s_barrier
    s_cmp_eq_u32 s43, 1
    s_cbranch_scc1 gl_7a
    s_add_u32 s37, s37, 128
    s_add_u32 s38, s38, s39
    buffer_load_dwordx4 v[228:231], v4, s[8:11], s37 offen sc1
    buffer_load_dwordx4 v[232:235], v5, s[8:11], s37 offen sc1
    buffer_load_dwordx4 v[236:239], v6, s[8:11], s37 offen sc1
    buffer_load_dwordx4 v[240:243], v7, s[8:11], s37 offen sc1
    buffer_load_dwordx4 v[244:247], v8, s[12:15], s38 offen
    buffer_load_dwordx4 v[248:251], v9, s[12:15], s38 offen
gl_7a:
    ds_read_b64_tr_b16 v[160:161], v227 offset:0
    ds_read_b64_tr_b16 v[162:163], v227 offset:1152
    ds_read_b64_tr_b16 v[164:165], v227 offset:32
    ds_read_b64_tr_b16 v[166:167], v227 offset:1184
    ds_read_b64_tr_b16 v[168:169], v227 offset:64
    ds_read_b64_tr_b16 v[170:171], v227 offset:1216
    ds_read_b64_tr_b16 v[172:173], v227 offset:96
    ds_read_b64_tr_b16 v[174:175], v227 offset:1248
    ds_read_b128 v[192:195], v226 offset:0
    ds_read_b128 v[196:199], v226 offset:2560
    ds_read_b128 v[200:203], v226 offset:5120
    ds_read_b128 v[204:207], v226 offset:7680
    ds_read_b64_tr_b16 v[176:177], v227 offset:9216
    ds_read_b64_tr_b16 v[178:179], v227 offset:10368
    ds_read_b64_tr_b16 v[180:181], v227 offset:9248
    ds_read_b64_tr_b16 v[182:183], v227 offset:10400
    ds_read_b64_tr_b16 v[184:185], v227 offset:9280
    ds_read_b64_tr_b16 v[186:187], v227 offset:10432
    ds_read_b64_tr_b16 v[188:189], v227 offset:9312
    ds_read_b64_tr_b16 v[190:191], v227 offset:10464
    ds_read_b128 v[208:211], v226 offset:64
    ds_read_b128 v[212:215], v226 offset:2624
    ds_read_b128 v[216:219], v226 offset:5184
    ds_read_b128 v[220:223], v226 offset:7744
    s_waitcnt lgkmcnt(12)
    v_mfma_f32_16x16x32_bf16 v[64:67], v[160:163], v[192:195], v[64:67]
    v_mfma_f32_16x16x32_bf16 v[68:71], v[160:163], v[196:199], v[68:71]
    v_mfma_f32_16x16x32_bf16 v[72:75], v[160:163], v[200:203], v[72:75]
    v_mfma_f32_16x16x32_bf16 v[76:79], v[160:163], v[204:207], v[76:79]
    v_mfma_f32_16x16x32_bf16 v[80:83], v[164:167], v[192:195], v[80:83]
    v_mfma_f32_16x16x32_bf16 v[84:87], v[164:167], v[196:199], v[84:87]
    v_mfma_f32_16x16x32_bf16 v[88:91], v[164:167], v[200:203], v[88:91]
    v_mfma_f32_16x16x32_bf16 v[92:95], v[164:167], v[204:207], v[92:95]
    v_mfma_f32_16x16x32_bf16 v[96:99], v[168:171], v[192:195], v[96:99]
    v_mfma_f32_16x16x32_bf16 v[100:103], v[168:171], v[196:199], v[100:103]
    v_mfma_f32_16x16x32_bf16 v[104:107], v[168:171], v[200:203], v[104:107]
    v_mfma_f32_16x16x32_bf16 v[108:111], v[168:171], v[204:207], v[108:111]
    v_mfma_f32_16x16x32_bf16 v[112:115], v[172:175], v[192:195], v[112:115]
    v_mfma_f32_16x16x32_bf16 v[116:119], v[172:175], v[196:199], v[116:119]
    v_mfma_f32_16x16x32_bf16 v[120:123], v[172:175], v[200:203], v[120:123]
    v_mfma_f32_16x16x32_bf16 v[124:127], v[172:175], v[204:207], v[124:127]
    s_waitcnt lgkmcnt(0)
    v_mfma_f32_16x16x32_bf16 v[64:67], v[176:179], v[208:211], v[64:67]
    v_mfma_f32_16x16x32_bf16 v[68:71], v[176:179], v[212:215], v[68:71]
    v_mfma_f32_16x16x32_bf16 v[72:75], v[176:179], v[216:219], v[72:75]
    v_mfma_f32_16x16x32_bf16 v[76:79], v[176:179], v[220:223], v[76:79]
    v_mfma_f32_16x16x32_bf16 v[80:83], v[180:183], v[208:211], v[80:83]
    v_mfma_f32_16x16x32_bf16 v[84:87], v[180:183], v[212:215], v[84:87]
    v_mfma_f32_16x16x32_bf16 v[88:91], v[180:183], v[216:219], v[88:91]
    v_mfma_f32_16x16x32_bf16 v[92:95], v[180:183], v[220:223], v[92:95]
    v_mfma_f32_16x16x32_bf16 v[96:99], v[184:187], v[208:211], v[96:99]
    v_mfma_f32_16x16x32_bf16 v[100:103], v[184:187], v[212:215], v[100:103]
    v_mfma_f32_16x16x32_bf16 v[104:107], v[184:187], v[216:219], v[104:107]
    v_mfma_f32_16x16x32_bf16 v[108:111], v[184:187], v[220:223], v[108:111]
    v_mfma_f32_16x16x32_bf16 v[112:115], v[188:191], v[208:211], v[112:115]
    v_mfma_f32_16x16x32_bf16 v[116:119], v[188:191], v[212:215], v[116:119]
    v_mfma_f32_16x16x32_bf16 v[120:123], v[188:191], v[216:219], v[120:123]
    v_mfma_f32_16x16x32_bf16 v[124:127], v[188:191], v[220:223], v[124:127]
    s_cmp_eq_u32 s43, 1
    s_cbranch_scc1 gl_7b
    s_waitcnt vmcnt(6)
    ds_write_b128 v12, v[128:131] offset:0
    ds_write_b128 v12, v[132:135] offset:10240
    ds_write_b128 v12, v[136:139] offset:20480
    ds_write_b128 v12, v[140:143] offset:30720
    ds_write_b128 v13, v[144:147] offset:0
    ds_write_b128 v13, v[148:151] offset:9216
    s_waitcnt lgkmcnt(0)
    s_branch gl_7c
gl_7b:
gl_7c:
    s_barrier
    s_sub_u32 s43, s43, 1
    s_cmp_lg_u32 s43, 0
    s_cbranch_scc1 gk_5
    s_nop 7
    s_nop 7
    v_lshrrev_b32 v1, 6, v0
    v_and_b32 v2, 3, v1
    v_lshrrev_b32 v3, 2, v1
    v_and_b32 v16, 63, v0
    v_and_b32 v17, 15, v16
    v_lshrrev_b32 v18, 4, v16
    v_lshl_add_u32 v19, v2, 6, v17
    v_add_u32 v19, s32, v19
    v_mul_lo_u32 v19, v19, s59
    v_lshlrev_b32 v20, 2, v18
    v_lshl_add_u32 v20, v3, 6, v20
    v_lshlrev_b32 v20, 1, v20
    v_add_u32 v20, s42, v20
    v_add_u32 v19, v19, v20
    s_lshl_b32 s44, s59, 4
    s_mov_b32 s45, s58
    s_cmp_ge_u32 s60, 832
    s_cbranch_scc1 wk_epi_b
    v_cvt_pk_bf16_f32 v22, v64, v65
    v_cvt_pk_bf16_f32 v23, v66, v67
    buffer_store_dwordx2 v[22:23], v19, s[8:11], s45 offen offset:0 sc1
    v_cvt_pk_bf16_f32 v24, v80, v81
    v_cvt_pk_bf16_f32 v25, v82, v83
    buffer_store_dwordx2 v[24:25], v19, s[8:11], s45 offen offset:32 sc1
    v_cvt_pk_bf16_f32 v26, v96, v97
    v_cvt_pk_bf16_f32 v27, v98, v99
    buffer_store_dwordx2 v[26:27], v19, s[8:11], s45 offen offset:64 sc1
    v_cvt_pk_bf16_f32 v28, v112, v113
    v_cvt_pk_bf16_f32 v29, v114, v115
    buffer_store_dwordx2 v[28:29], v19, s[8:11], s45 offen offset:96 sc1
    s_add_u32 s45, s45, s44
    s_nop 0
    v_cvt_pk_bf16_f32 v22, v68, v69
    v_cvt_pk_bf16_f32 v23, v70, v71
    buffer_store_dwordx2 v[22:23], v19, s[8:11], s45 offen offset:0 sc1
    v_cvt_pk_bf16_f32 v24, v84, v85
    v_cvt_pk_bf16_f32 v25, v86, v87
    buffer_store_dwordx2 v[24:25], v19, s[8:11], s45 offen offset:32 sc1
    v_cvt_pk_bf16_f32 v26, v100, v101
    v_cvt_pk_bf16_f32 v27, v102, v103
    buffer_store_dwordx2 v[26:27], v19, s[8:11], s45 offen offset:64 sc1
    v_cvt_pk_bf16_f32 v28, v116, v117
    v_cvt_pk_bf16_f32 v29, v118, v119
    buffer_store_dwordx2 v[28:29], v19, s[8:11], s45 offen offset:96 sc1
    s_add_u32 s45, s45, s44
    s_nop 0
    v_cvt_pk_bf16_f32 v22, v72, v73
    v_cvt_pk_bf16_f32 v23, v74, v75
    buffer_store_dwordx2 v[22:23], v19, s[8:11], s45 offen offset:0 sc1
    v_cvt_pk_bf16_f32 v24, v88, v89
    v_cvt_pk_bf16_f32 v25, v90, v91
    buffer_store_dwordx2 v[24:25], v19, s[8:11], s45 offen offset:32 sc1
    v_cvt_pk_bf16_f32 v26, v104, v105
    v_cvt_pk_bf16_f32 v27, v106, v107
    buffer_store_dwordx2 v[26:27], v19, s[8:11], s45 offen offset:64 sc1
    v_cvt_pk_bf16_f32 v28, v120, v121
    v_cvt_pk_bf16_f32 v29, v122, v123
    buffer_store_dwordx2 v[28:29], v19, s[8:11], s45 offen offset:96 sc1
    s_add_u32 s45, s45, s44
    s_nop 0
    v_cvt_pk_bf16_f32 v22, v76, v77
    v_cvt_pk_bf16_f32 v23, v78, v79
    buffer_store_dwordx2 v[22:23], v19, s[8:11], s45 offen offset:0 sc1
    v_cvt_pk_bf16_f32 v24, v92, v93
    v_cvt_pk_bf16_f32 v25, v94, v95
    buffer_store_dwordx2 v[24:25], v19, s[8:11], s45 offen offset:32 sc1
    v_cvt_pk_bf16_f32 v26, v108, v109
    v_cvt_pk_bf16_f32 v27, v110, v111
    buffer_store_dwordx2 v[26:27], v19, s[8:11], s45 offen offset:64 sc1
    v_cvt_pk_bf16_f32 v28, v124, v125
    v_cvt_pk_bf16_f32 v29, v126, v127
    buffer_store_dwordx2 v[28:29], v19, s[8:11], s45 offen offset:96 sc1
    s_add_u32 s45, s45, s44
    s_nop 0
    s_cmp_ge_u32 s60, 576
    s_cbranch_scc1 wk_next
    s_lshl_b32 s33, s30, 7
    s_add_u32 s33, s33, 103719040
    s_branch wk_signal
wk_epi_b:
    s_cmp_ge_u32 s60, 1056
    s_cbranch_scc1 wk_epi_b2
    buffer_load_dwordx2 v[24:25], v20, s[24:27], 0 offen offset:0
    buffer_load_dwordx2 v[26:27], v20, s[24:27], 0 offen offset:32
    buffer_load_dwordx2 v[28:29], v20, s[24:27], 0 offen offset:64
    buffer_load_dwordx2 v[30:31], v20, s[24:27], 0 offen offset:96
    s_branch wk_epi_bb
wk_epi_b2:
    buffer_load_dwordx2 v[24:25], v20, s[64:67], 0 offen offset:0
    buffer_load_dwordx2 v[26:27], v20, s[64:67], 0 offen offset:32
    buffer_load_dwordx2 v[28:29], v20, s[64:67], 0 offen offset:64
    buffer_load_dwordx2 v[30:31], v20, s[64:67], 0 offen offset:96
wk_epi_bb:
    s_waitcnt vmcnt(0)
    v_lshlrev_b32 v32, 16, v24
    v_and_b32 v33, 0xffff0000, v24
    v_lshlrev_b32 v34, 16, v25
    v_and_b32 v35, 0xffff0000, v25
    v_lshlrev_b32 v36, 16, v26
    v_and_b32 v37, 0xffff0000, v26
    v_lshlrev_b32 v38, 16, v27
    v_and_b32 v39, 0xffff0000, v27
    v_lshlrev_b32 v40, 16, v28
    v_and_b32 v41, 0xffff0000, v28
    v_lshlrev_b32 v42, 16, v29
    v_and_b32 v43, 0xffff0000, v29
    v_lshlrev_b32 v44, 16, v30
    v_and_b32 v45, 0xffff0000, v30
    v_lshlrev_b32 v46, 16, v31
    v_and_b32 v47, 0xffff0000, v31
    s_cmp_ge_u32 s60, 1056
    s_cbranch_scc1 wk_epi_m2
    s_mov_b32 s46, 0x3d372713
    s_mov_b32 s47, 0x40135761
    v_cvt_pk_bf16_f32 v21, v64, v64
    v_lshlrev_b32 v64, 16, v21
    v_add_f32 v64, v64, v32
    v_cvt_pk_bf16_f32 v21, v64, v64
    v_lshlrev_b32 v64, 16, v21
    v_mul_f32 v21, v64, v64
    v_fma_f32 v21, v21, s46, 1.0
    v_mul_f32 v21, v21, v64
    v_mul_f32 v21, s47, v21
    v_exp_f32 v21, v21
    s_nop 0
    v_add_f32 v21, 1.0, v21
    v_rcp_f32 v21, v21
    s_nop 0
    v_fma_f32 v21, v21, -2.0, 1.0
    v_add_f32 v21, 1.0, v21
    v_mul_f32 v64, 0.5, v64
    v_mul_f32 v64, v64, v21
    v_cvt_pk_bf16_f32 v21, v65, v65
    v_lshlrev_b32 v65, 16, v21
    v_add_f32 v65, v65, v33
    v_cvt_pk_bf16_f32 v21, v65, v65
    v_lshlrev_b32 v65, 16, v21
    v_mul_f32 v21, v65, v65
    v_fma_f32 v21, v21, s46, 1.0
    v_mul_f32 v21, v21, v65
    v_mul_f32 v21, s47, v21
    v_exp_f32 v21, v21
    s_nop 0
    v_add_f32 v21, 1.0, v21
    v_rcp_f32 v21, v21
    s_nop 0
    v_fma_f32 v21, v21, -2.0, 1.0
    v_add_f32 v21, 1.0, v21
    v_mul_f32 v65, 0.5, v65
    v_mul_f32 v65, v65, v21
    v_cvt_pk_bf16_f32 v21, v66, v66
    v_lshlrev_b32 v66, 16, v21
    v_add_f32 v66, v66, v34
    v_cvt_pk_bf16_f32 v21, v66, v66
    v_lshlrev_b32 v66, 16, v21
    v_mul_f32 v21, v66, v66
    v_fma_f32 v21, v21, s46, 1.0
    v_mul_f32 v21, v21, v66
    v_mul_f32 v21, s47, v21
    v_exp_f32 v21, v21
    s_nop 0
    v_add_f32 v21, 1.0, v21
    v_rcp_f32 v21, v21
    s_nop 0
    v_fma_f32 v21, v21, -2.0, 1.0
    v_add_f32 v21, 1.0, v21
    v_mul_f32 v66, 0.5, v66
    v_mul_f32 v66, v66, v21
    v_cvt_pk_bf16_f32 v21, v67, v67
    v_lshlrev_b32 v67, 16, v21
    v_add_f32 v67, v67, v35
    v_cvt_pk_bf16_f32 v21, v67, v67
    v_lshlrev_b32 v67, 16, v21
    v_mul_f32 v21, v67, v67
    v_fma_f32 v21, v21, s46, 1.0
    v_mul_f32 v21, v21, v67
    v_mul_f32 v21, s47, v21
    v_exp_f32 v21, v21
    s_nop 0
    v_add_f32 v21, 1.0, v21
    v_rcp_f32 v21, v21
    s_nop 0
    v_fma_f32 v21, v21, -2.0, 1.0
    v_add_f32 v21, 1.0, v21
    v_mul_f32 v67, 0.5, v67
    v_mul_f32 v67, v67, v21
    v_cvt_pk_bf16_f32 v22, v64, v65
    v_cvt_pk_bf16_f32 v23, v66, v67
    buffer_store_dwordx2 v[22:23], v19, s[8:11], s45 offen offset:0 sc1
    s_nop 1
    v_cvt_pk_bf16_f32 v21, v80, v80
    v_lshlrev_b32 v80, 16, v21
    v_add_f32 v80, v80, v36
    v_cvt_pk_bf16_f32 v21, v80, v80
    v_lshlrev_b32 v80, 16, v21
    v_mul_f32 v21, v80, v80
    v_fma_f32 v21, v21, s46, 1.0
    v_mul_f32 v21, v21, v80
    v_mul_f32 v21, s47, v21
    v_exp_f32 v21, v21
    s_nop 0
    v_add_f32 v21, 1.0, v21
    v_rcp_f32 v21, v21
    s_nop 0
    v_fma_f32 v21, v21, -2.0, 1.0
    v_add_f32 v21, 1.0, v21
    v_mul_f32 v80, 0.5, v80
    v_mul_f32 v80, v80, v21
    v_cvt_pk_bf16_f32 v21, v81, v81
    v_lshlrev_b32 v81, 16, v21
    v_add_f32 v81, v81, v37
    v_cvt_pk_bf16_f32 v21, v81, v81
    v_lshlrev_b32 v81, 16, v21
    v_mul_f32 v21, v81, v81
    v_fma_f32 v21, v21, s46, 1.0
    v_mul_f32 v21, v21, v81
    v_mul_f32 v21, s47, v21
    v_exp_f32 v21, v21
    s_nop 0
    v_add_f32 v21, 1.0, v21
    v_rcp_f32 v21, v21
    s_nop 0
    v_fma_f32 v21, v21, -2.0, 1.0
    v_add_f32 v21, 1.0, v21
    v_mul_f32 v81, 0.5, v81
    v_mul_f32 v81, v81, v21
    v_cvt_pk_bf16_f32 v21, v82, v82
    v_lshlrev_b32 v82, 16, v21
    v_add_f32 v82, v82, v38
    v_cvt_pk_bf16_f32 v21, v82, v82
    v_lshlrev_b32 v82, 16, v21
    v_mul_f32 v21, v82, v82
    v_fma_f32 v21, v21, s46, 1.0
    v_mul_f32 v21, v21, v82
    v_mul_f32 v21, s47, v21
    v_exp_f32 v21, v21
    s_nop 0
    v_add_f32 v21, 1.0, v21
    v_rcp_f32 v21, v21
    s_nop 0
    v_fma_f32 v21, v21, -2.0, 1.0
    v_add_f32 v21, 1.0, v21
    v_mul_f32 v82, 0.5, v82
    v_mul_f32 v82, v82, v21
    v_cvt_pk_bf16_f32 v21, v83, v83
    v_lshlrev_b32 v83, 16, v21
    v_add_f32 v83, v83, v39
    v_cvt_pk_bf16_f32 v21, v83, v83
    v_lshlrev_b32 v83, 16, v21
    v_mul_f32 v21, v83, v83
    v_fma_f32 v21, v21, s46, 1.0
    v_mul_f32 v21, v21, v83
    v_mul_f32 v21, s47, v21
    v_exp_f32 v21, v21
    s_nop 0
    v_add_f32 v21, 1.0, v21
    v_rcp_f32 v21, v21
    s_nop 0
    v_fma_f32 v21, v21, -2.0, 1.0
    v_add_f32 v21, 1.0, v21
    v_mul_f32 v83, 0.5, v83
    v_mul_f32 v83, v83, v21
    v_cvt_pk_bf16_f32 v22, v80, v81
    v_cvt_pk_bf16_f32 v23, v82, v83
    buffer_store_dwordx2 v[22:23], v19, s[8:11], s45 offen offset:32 sc1
    s_nop 1
    v_cvt_pk_bf16_f32 v21, v96, v96
    v_lshlrev_b32 v96, 16, v21
    v_add_f32 v96, v96, v40
    v_cvt_pk_bf16_f32 v21, v96, v96
    v_lshlrev_b32 v96, 16, v21
    v_mul_f32 v21, v96, v96
    v_fma_f32 v21, v21, s46, 1.0
    v_mul_f32 v21, v21, v96
    v_mul_f32 v21, s47, v21
    v_exp_f32 v21, v21
    s_nop 0
    v_add_f32 v21, 1.0, v21
    v_rcp_f32 v21, v21
    s_nop 0
    v_fma_f32 v21, v21, -2.0, 1.0
    v_add_f32 v21, 1.0, v21
    v_mul_f32 v96, 0.5, v96
    v_mul_f32 v96, v96, v21
    v_cvt_pk_bf16_f32 v21, v97, v97
    v_lshlrev_b32 v97, 16, v21
    v_add_f32 v97, v97, v41
    v_cvt_pk_bf16_f32 v21, v97, v97
    v_lshlrev_b32 v97, 16, v21
    v_mul_f32 v21, v97, v97
    v_fma_f32 v21, v21, s46, 1.0
    v_mul_f32 v21, v21, v97
    v_mul_f32 v21, s47, v21
    v_exp_f32 v21, v21
    s_nop 0
    v_add_f32 v21, 1.0, v21
    v_rcp_f32 v21, v21
    s_nop 0
    v_fma_f32 v21, v21, -2.0, 1.0
    v_add_f32 v21, 1.0, v21
    v_mul_f32 v97, 0.5, v97
    v_mul_f32 v97, v97, v21
    v_cvt_pk_bf16_f32 v21, v98, v98
    v_lshlrev_b32 v98, 16, v21
    v_add_f32 v98, v98, v42
    v_cvt_pk_bf16_f32 v21, v98, v98
    v_lshlrev_b32 v98, 16, v21
    v_mul_f32 v21, v98, v98
    v_fma_f32 v21, v21, s46, 1.0
    v_mul_f32 v21, v21, v98
    v_mul_f32 v21, s47, v21
    v_exp_f32 v21, v21
    s_nop 0
    v_add_f32 v21, 1.0, v21
    v_rcp_f32 v21, v21
    s_nop 0
    v_fma_f32 v21, v21, -2.0, 1.0
    v_add_f32 v21, 1.0, v21
    v_mul_f32 v98, 0.5, v98
    v_mul_f32 v98, v98, v21
    v_cvt_pk_bf16_f32 v21, v99, v99
    v_lshlrev_b32 v99, 16, v21
    v_add_f32 v99, v99, v43
    v_cvt_pk_bf16_f32 v21, v99, v99
    v_lshlrev_b32 v99, 16, v21
    v_mul_f32 v21, v99, v99
    v_fma_f32 v21, v21, s46, 1.0
    v_mul_f32 v21, v21, v99
    v_mul_f32 v21, s47, v21
    v_exp_f32 v21, v21
    s_nop 0
    v_add_f32 v21, 1.0, v21
    v_rcp_f32 v21, v21
    s_nop 0
    v_fma_f32 v21, v21, -2.0, 1.0
    v_add_f32 v21, 1.0, v21
    v_mul_f32 v99, 0.5, v99
    v_mul_f32 v99, v99, v21
    v_cvt_pk_bf16_f32 v22, v96, v97
    v_cvt_pk_bf16_f32 v23, v98, v99
    buffer_store_dwordx2 v[22:23], v19, s[8:11], s45 offen offset:64 sc1
    s_nop 1
    v_cvt_pk_bf16_f32 v21, v112, v112
    v_lshlrev_b32 v112, 16, v21
    v_add_f32 v112, v112, v44
    v_cvt_pk_bf16_f32 v21, v112, v112
    v_lshlrev_b32 v112, 16, v21
    v_mul_f32 v21, v112, v112
    v_fma_f32 v21, v21, s46, 1.0
    v_mul_f32 v21, v21, v112
    v_mul_f32 v21, s47, v21
    v_exp_f32 v21, v21
    s_nop 0
    v_add_f32 v21, 1.0, v21
    v_rcp_f32 v21, v21
    s_nop 0
    v_fma_f32 v21, v21, -2.0, 1.0
    v_add_f32 v21, 1.0, v21
    v_mul_f32 v112, 0.5, v112
    v_mul_f32 v112, v112, v21
    v_cvt_pk_bf16_f32 v21, v113, v113
    v_lshlrev_b32 v113, 16, v21
    v_add_f32 v113, v113, v45
    v_cvt_pk_bf16_f32 v21, v113, v113
    v_lshlrev_b32 v113, 16, v21
    v_mul_f32 v21, v113, v113
    v_fma_f32 v21, v21, s46, 1.0
    v_mul_f32 v21, v21, v113
    v_mul_f32 v21, s47, v21
    v_exp_f32 v21, v21
    s_nop 0
    v_add_f32 v21, 1.0, v21
    v_rcp_f32 v21, v21
    s_nop 0
    v_fma_f32 v21, v21, -2.0, 1.0
    v_add_f32 v21, 1.0, v21
    v_mul_f32 v113, 0.5, v113
    v_mul_f32 v113, v113, v21
    v_cvt_pk_bf16_f32 v21, v114, v114
    v_lshlrev_b32 v114, 16, v21
    v_add_f32 v114, v114, v46
    v_cvt_pk_bf16_f32 v21, v114, v114
    v_lshlrev_b32 v114, 16, v21
    v_mul_f32 v21, v114, v114
    v_fma_f32 v21, v21, s46, 1.0
    v_mul_f32 v21, v21, v114
    v_mul_f32 v21, s47, v21
    v_exp_f32 v21, v21
    s_nop 0
    v_add_f32 v21, 1.0, v21
    v_rcp_f32 v21, v21
    s_nop 0
    v_fma_f32 v21, v21, -2.0, 1.0
    v_add_f32 v21, 1.0, v21
    v_mul_f32 v114, 0.5, v114
    v_mul_f32 v114, v114, v21
    v_cvt_pk_bf16_f32 v21, v115, v115
    v_lshlrev_b32 v115, 16, v21
    v_add_f32 v115, v115, v47
    v_cvt_pk_bf16_f32 v21, v115, v115
    v_lshlrev_b32 v115, 16, v21
    v_mul_f32 v21, v115, v115
    v_fma_f32 v21, v21, s46, 1.0
    v_mul_f32 v21, v21, v115
    v_mul_f32 v21, s47, v21
    v_exp_f32 v21, v21
    s_nop 0
    v_add_f32 v21, 1.0, v21
    v_rcp_f32 v21, v21
    s_nop 0
    v_fma_f32 v21, v21, -2.0, 1.0
    v_add_f32 v21, 1.0, v21
    v_mul_f32 v115, 0.5, v115
    v_mul_f32 v115, v115, v21
    v_cvt_pk_bf16_f32 v22, v112, v113
    v_cvt_pk_bf16_f32 v23, v114, v115
    buffer_store_dwordx2 v[22:23], v19, s[8:11], s45 offen offset:96 sc1
    s_nop 1
    s_add_u32 s45, s45, s44
    v_cvt_pk_bf16_f32 v21, v68, v68
    v_lshlrev_b32 v68, 16, v21
    v_add_f32 v68, v68, v32
    v_cvt_pk_bf16_f32 v21, v68, v68
    v_lshlrev_b32 v68, 16, v21
    v_mul_f32 v21, v68, v68
    v_fma_f32 v21, v21, s46, 1.0
    v_mul_f32 v21, v21, v68
    v_mul_f32 v21, s47, v21
    v_exp_f32 v21, v21
    s_nop 0
    v_add_f32 v21, 1.0, v21
    v_rcp_f32 v21, v21
    s_nop 0
    v_fma_f32 v21, v21, -2.0, 1.0
    v_add_f32 v21, 1.0, v21
    v_mul_f32 v68, 0.5, v68
    v_mul_f32 v68, v68, v21
    v_cvt_pk_bf16_f32 v21, v69, v69
    v_lshlrev_b32 v69, 16, v21
    v_add_f32 v69, v69, v33
    v_cvt_pk_bf16_f32 v21, v69, v69
    v_lshlrev_b32 v69, 16, v21
    v_mul_f32 v21, v69, v69
    v_fma_f32 v21, v21, s46, 1.0
    v_mul_f32 v21, v21, v69
    v_mul_f32 v21, s47, v21
    v_exp_f32 v21, v21
    s_nop 0
    v_add_f32 v21, 1.0, v21
    v_rcp_f32 v21, v21
    s_nop 0
    v_fma_f32 v21, v21, -2.0, 1.0
    v_add_f32 v21, 1.0, v21
    v_mul_f32 v69, 0.5, v69
    v_mul_f32 v69, v69, v21
    v_cvt_pk_bf16_f32 v21, v70, v70
    v_lshlrev_b32 v70, 16, v21
    v_add_f32 v70, v70, v34
    v_cvt_pk_bf16_f32 v21, v70, v70
    v_lshlrev_b32 v70, 16, v21
    v_mul_f32 v21, v70, v70
    v_fma_f32 v21, v21, s46, 1.0
    v_mul_f32 v21, v21, v70
    v_mul_f32 v21, s47, v21
    v_exp_f32 v21, v21
    s_nop 0
    v_add_f32 v21, 1.0, v21
    v_rcp_f32 v21, v21
    s_nop 0
    v_fma_f32 v21, v21, -2.0, 1.0
    v_add_f32 v21, 1.0, v21
    v_mul_f32 v70, 0.5, v70
    v_mul_f32 v70, v70, v21
    v_cvt_pk_bf16_f32 v21, v71, v71
    v_lshlrev_b32 v71, 16, v21
    v_add_f32 v71, v71, v35
    v_cvt_pk_bf16_f32 v21, v71, v71
    v_lshlrev_b32 v71, 16, v21
    v_mul_f32 v21, v71, v71
    v_fma_f32 v21, v21, s46, 1.0
    v_mul_f32 v21, v21, v71
    v_mul_f32 v21, s47, v21
    v_exp_f32 v21, v21
    s_nop 0
    v_add_f32 v21, 1.0, v21
    v_rcp_f32 v21, v21
    s_nop 0
    v_fma_f32 v21, v21, -2.0, 1.0
    v_add_f32 v21, 1.0, v21
    v_mul_f32 v71, 0.5, v71
    v_mul_f32 v71, v71, v21
    v_cvt_pk_bf16_f32 v22, v68, v69
    v_cvt_pk_bf16_f32 v23, v70, v71
    buffer_store_dwordx2 v[22:23], v19, s[8:11], s45 offen offset:0 sc1
    s_nop 1
    v_cvt_pk_bf16_f32 v21, v84, v84
    v_lshlrev_b32 v84, 16, v21
    v_add_f32 v84, v84, v36
    v_cvt_pk_bf16_f32 v21, v84, v84
    v_lshlrev_b32 v84, 16, v21
    v_mul_f32 v21, v84, v84
    v_fma_f32 v21, v21, s46, 1.0
    v_mul_f32 v21, v21, v84
    v_mul_f32 v21, s47, v21
    v_exp_f32 v21, v21
    s_nop 0
    v_add_f32 v21, 1.0, v21
    v_rcp_f32 v21, v21
    s_nop 0
    v_fma_f32 v21, v21, -2.0, 1.0
    v_add_f32 v21, 1.0, v21
    v_mul_f32 v84, 0.5, v84
    v_mul_f32 v84, v84, v21
    v_cvt_pk_bf16_f32 v21, v85, v85
    v_lshlrev_b32 v85, 16, v21
    v_add_f32 v85, v85, v37
    v_cvt_pk_bf16_f32 v21, v85, v85
    v_lshlrev_b32 v85, 16, v21
    v_mul_f32 v21, v85, v85
    v_fma_f32 v21, v21, s46, 1.0
    v_mul_f32 v21, v21, v85
    v_mul_f32 v21, s47, v21
    v_exp_f32 v21, v21
    s_nop 0
    v_add_f32 v21, 1.0, v21
    v_rcp_f32 v21, v21
    s_nop 0
    v_fma_f32 v21, v21, -2.0, 1.0
    v_add_f32 v21, 1.0, v21
    v_mul_f32 v85, 0.5, v85
    v_mul_f32 v85, v85, v21
    v_cvt_pk_bf16_f32 v21, v86, v86
    v_lshlrev_b32 v86, 16, v21
    v_add_f32 v86, v86, v38
    v_cvt_pk_bf16_f32 v21, v86, v86
    v_lshlrev_b32 v86, 16, v21
    v_mul_f32 v21, v86, v86
    v_fma_f32 v21, v21, s46, 1.0
    v_mul_f32 v21, v21, v86
    v_mul_f32 v21, s47, v21
    v_exp_f32 v21, v21
    s_nop 0
    v_add_f32 v21, 1.0, v21
    v_rcp_f32 v21, v21
    s_nop 0
    v_fma_f32 v21, v21, -2.0, 1.0
    v_add_f32 v21, 1.0, v21
    v_mul_f32 v86, 0.5, v86
    v_mul_f32 v86, v86, v21
    v_cvt_pk_bf16_f32 v21, v87, v87
    v_lshlrev_b32 v87, 16, v21
    v_add_f32 v87, v87, v39
    v_cvt_pk_bf16_f32 v21, v87, v87
    v_lshlrev_b32 v87, 16, v21
    v_mul_f32 v21, v87, v87
    v_fma_f32 v21, v21, s46, 1.0
    v_mul_f32 v21, v21, v87
    v_mul_f32 v21, s47, v21
    v_exp_f32 v21, v21
    s_nop 0
    v_add_f32 v21, 1.0, v21
    v_rcp_f32 v21, v21
    s_nop 0
    v_fma_f32 v21, v21, -2.0, 1.0
    v_add_f32 v21, 1.0, v21
    v_mul_f32 v87, 0.5, v87
    v_mul_f32 v87, v87, v21
    v_cvt_pk_bf16_f32 v22, v84, v85
    v_cvt_pk_bf16_f32 v23, v86, v87
    buffer_store_dwordx2 v[22:23], v19, s[8:11], s45 offen offset:32 sc1
    s_nop 1
    v_cvt_pk_bf16_f32 v21, v100, v100
    v_lshlrev_b32 v100, 16, v21
    v_add_f32 v100, v100, v40
    v_cvt_pk_bf16_f32 v21, v100, v100
    v_lshlrev_b32 v100, 16, v21
    v_mul_f32 v21, v100, v100
    v_fma_f32 v21, v21, s46, 1.0
    v_mul_f32 v21, v21, v100
    v_mul_f32 v21, s47, v21
    v_exp_f32 v21, v21
    s_nop 0
    v_add_f32 v21, 1.0, v21
    v_rcp_f32 v21, v21
    s_nop 0
    v_fma_f32 v21, v21, -2.0, 1.0
    v_add_f32 v21, 1.0, v21
    v_mul_f32 v100, 0.5, v100
    v_mul_f32 v100, v100, v21
    v_cvt_pk_bf16_f32 v21, v101, v101
    v_lshlrev_b32 v101, 16, v21
    v_add_f32 v101, v101, v41
    v_cvt_pk_bf16_f32 v21, v101, v101
    v_lshlrev_b32 v101, 16, v21
    v_mul_f32 v21, v101, v101
    v_fma_f32 v21, v21, s46, 1.0
    v_mul_f32 v21, v21, v101
    v_mul_f32 v21, s47, v21
    v_exp_f32 v21, v21
    s_nop 0
    v_add_f32 v21, 1.0, v21
    v_rcp_f32 v21, v21
    s_nop 0
    v_fma_f32 v21, v21, -2.0, 1.0
    v_add_f32 v21, 1.0, v21
    v_mul_f32 v101, 0.5, v101
    v_mul_f32 v101, v101, v21
    v_cvt_pk_bf16_f32 v21, v102, v102
    v_lshlrev_b32 v102, 16, v21
    v_add_f32 v102, v102, v42
    v_cvt_pk_bf16_f32 v21, v102, v102
    v_lshlrev_b32 v102, 16, v21
    v_mul_f32 v21, v102, v102
    v_fma_f32 v21, v21, s46, 1.0
    v_mul_f32 v21, v21, v102
    v_mul_f32 v21, s47, v21
    v_exp_f32 v21, v21
    s_nop 0
    v_add_f32 v21, 1.0, v21
    v_rcp_f32 v21, v21
    s_nop 0
    v_fma_f32 v21, v21, -2.0, 1.0
    v_add_f32 v21, 1.0, v21
    v_mul_f32 v102, 0.5, v102
    v_mul_f32 v102, v102, v21
    v_cvt_pk_bf16_f32 v21, v103, v103
    v_lshlrev_b32 v103, 16, v21
    v_add_f32 v103, v103, v43
    v_cvt_pk_bf16_f32 v21, v103, v103
    v_lshlrev_b32 v103, 16, v21
    v_mul_f32 v21, v103, v103
    v_fma_f32 v21, v21, s46, 1.0
    v_mul_f32 v21, v21, v103
    v_mul_f32 v21, s47, v21
    v_exp_f32 v21, v21
    s_nop 0
    v_add_f32 v21, 1.0, v21
    v_rcp_f32 v21, v21
    s_nop 0
    v_fma_f32 v21, v21, -2.0, 1.0
    v_add_f32 v21, 1.0, v21
    v_mul_f32 v103, 0.5, v103
    v_mul_f32 v103, v103, v21
    v_cvt_pk_bf16_f32 v22, v100, v101
    v_cvt_pk_bf16_f32 v23, v102, v103
    buffer_store_dwordx2 v[22:23], v19, s[8:11], s45 offen offset:64 sc1
    s_nop 1
    v_cvt_pk_bf16_f32 v21, v116, v116
    v_lshlrev_b32 v116, 16, v21
    v_add_f32 v116, v116, v44
    v_cvt_pk_bf16_f32 v21, v116, v116
    v_lshlrev_b32 v116, 16, v21
    v_mul_f32 v21, v116, v116
    v_fma_f32 v21, v21, s46, 1.0
    v_mul_f32 v21, v21, v116
    v_mul_f32 v21, s47, v21
    v_exp_f32 v21, v21
    s_nop 0
    v_add_f32 v21, 1.0, v21
    v_rcp_f32 v21, v21
    s_nop 0
    v_fma_f32 v21, v21, -2.0, 1.0
    v_add_f32 v21, 1.0, v21
    v_mul_f32 v116, 0.5, v116
    v_mul_f32 v116, v116, v21
    v_cvt_pk_bf16_f32 v21, v117, v117
    v_lshlrev_b32 v117, 16, v21
    v_add_f32 v117, v117, v45
    v_cvt_pk_bf16_f32 v21, v117, v117
    v_lshlrev_b32 v117, 16, v21
    v_mul_f32 v21, v117, v117
    v_fma_f32 v21, v21, s46, 1.0
    v_mul_f32 v21, v21, v117
    v_mul_f32 v21, s47, v21
    v_exp_f32 v21, v21
    s_nop 0
    v_add_f32 v21, 1.0, v21
    v_rcp_f32 v21, v21
    s_nop 0
    v_fma_f32 v21, v21, -2.0, 1.0
    v_add_f32 v21, 1.0, v21
    v_mul_f32 v117, 0.5, v117
    v_mul_f32 v117, v117, v21
    v_cvt_pk_bf16_f32 v21, v118, v118
    v_lshlrev_b32 v118, 16, v21
    v_add_f32 v118, v118, v46
    v_cvt_pk_bf16_f32 v21, v118, v118
    v_lshlrev_b32 v118, 16, v21
    v_mul_f32 v21, v118, v118
    v_fma_f32 v21, v21, s46, 1.0
    v_mul_f32 v21, v21, v118
    v_mul_f32 v21, s47, v21
    v_exp_f32 v21, v21
    s_nop 0
    v_add_f32 v21, 1.0, v21
    v_rcp_f32 v21, v21
    s_nop 0
    v_fma_f32 v21, v21, -2.0, 1.0
    v_add_f32 v21, 1.0, v21
    v_mul_f32 v118, 0.5, v118
    v_mul_f32 v118, v118, v21
    v_cvt_pk_bf16_f32 v21, v119, v119
    v_lshlrev_b32 v119, 16, v21
    v_add_f32 v119, v119, v47
    v_cvt_pk_bf16_f32 v21, v119, v119
    v_lshlrev_b32 v119, 16, v21
    v_mul_f32 v21, v119, v119
    v_fma_f32 v21, v21, s46, 1.0
    v_mul_f32 v21, v21, v119
    v_mul_f32 v21, s47, v21
    v_exp_f32 v21, v21
    s_nop 0
    v_add_f32 v21, 1.0, v21
    v_rcp_f32 v21, v21
    s_nop 0
    v_fma_f32 v21, v21, -2.0, 1.0
    v_add_f32 v21, 1.0, v21
    v_mul_f32 v119, 0.5, v119
    v_mul_f32 v119, v119, v21
    v_cvt_pk_bf16_f32 v22, v116, v117
    v_cvt_pk_bf16_f32 v23, v118, v119
    buffer_store_dwordx2 v[22:23], v19, s[8:11], s45 offen offset:96 sc1
    s_nop 1
    s_add_u32 s45, s45, s44
    v_cvt_pk_bf16_f32 v21, v72, v72
    v_lshlrev_b32 v72, 16, v21
    v_add_f32 v72, v72, v32
    v_cvt_pk_bf16_f32 v21, v72, v72
    v_lshlrev_b32 v72, 16, v21
    v_mul_f32 v21, v72, v72
    v_fma_f32 v21, v21, s46, 1.0
    v_mul_f32 v21, v21, v72
    v_mul_f32 v21, s47, v21
    v_exp_f32 v21, v21
    s_nop 0
    v_add_f32 v21, 1.0, v21
    v_rcp_f32 v21, v21
    s_nop 0
    v_fma_f32 v21, v21, -2.0, 1.0
    v_add_f32 v21, 1.0, v21
    v_mul_f32 v72, 0.5, v72
    v_mul_f32 v72, v72, v21
    v_cvt_pk_bf16_f32 v21, v73, v73
    v_lshlrev_b32 v73, 16, v21
    v_add_f32 v73, v73, v33
    v_cvt_pk_bf16_f32 v21, v73, v73
    v_lshlrev_b32 v73, 16, v21
    v_mul_f32 v21, v73, v73
    v_fma_f32 v21, v21, s46, 1.0
    v_mul_f32 v21, v21, v73
    v_mul_f32 v21, s47, v21
    v_exp_f32 v21, v21
    s_nop 0
    v_add_f32 v21, 1.0, v21
    v_rcp_f32 v21, v21
    s_nop 0
    v_fma_f32 v21, v21, -2.0, 1.0
    v_add_f32 v21, 1.0, v21
    v_mul_f32 v73, 0.5, v73
    v_mul_f32 v73, v73, v21
    v_cvt_pk_bf16_f32 v21, v74, v74
    v_lshlrev_b32 v74, 16, v21
    v_add_f32 v74, v74, v34
    v_cvt_pk_bf16_f32 v21, v74, v74
    v_lshlrev_b32 v74, 16, v21
    v_mul_f32 v21, v74, v74
    v_fma_f32 v21, v21, s46, 1.0
    v_mul_f32 v21, v21, v74
    v_mul_f32 v21, s47, v21
    v_exp_f32 v21, v21
    s_nop 0
    v_add_f32 v21, 1.0, v21
    v_rcp_f32 v21, v21
    s_nop 0
    v_fma_f32 v21, v21, -2.0, 1.0
    v_add_f32 v21, 1.0, v21
    v_mul_f32 v74, 0.5, v74
    v_mul_f32 v74, v74, v21
    v_cvt_pk_bf16_f32 v21, v75, v75
    v_lshlrev_b32 v75, 16, v21
    v_add_f32 v75, v75, v35
    v_cvt_pk_bf16_f32 v21, v75, v75
    v_lshlrev_b32 v75, 16, v21
    v_mul_f32 v21, v75, v75
    v_fma_f32 v21, v21, s46, 1.0
    v_mul_f32 v21, v21, v75
    v_mul_f32 v21, s47, v21
    v_exp_f32 v21, v21
    s_nop 0
    v_add_f32 v21, 1.0, v21
    v_rcp_f32 v21, v21
    s_nop 0
    v_fma_f32 v21, v21, -2.0, 1.0
    v_add_f32 v21, 1.0, v21
    v_mul_f32 v75, 0.5, v75
    v_mul_f32 v75, v75, v21
    v_cvt_pk_bf16_f32 v22, v72, v73
    v_cvt_pk_bf16_f32 v23, v74, v75
    buffer_store_dwordx2 v[22:23], v19, s[8:11], s45 offen offset:0 sc1
    s_nop 1
    v_cvt_pk_bf16_f32 v21, v88, v88
    v_lshlrev_b32 v88, 16, v21
    v_add_f32 v88, v88, v36
    v_cvt_pk_bf16_f32 v21, v88, v88
    v_lshlrev_b32 v88, 16, v21
    v_mul_f32 v21, v88, v88
    v_fma_f32 v21, v21, s46, 1.0
    v_mul_f32 v21, v21, v88
    v_mul_f32 v21, s47, v21
    v_exp_f32 v21, v21
    s_nop 0
    v_add_f32 v21, 1.0, v21
    v_rcp_f32 v21, v21
    s_nop 0
    v_fma_f32 v21, v21, -2.0, 1.0
    v_add_f32 v21, 1.0, v21
    v_mul_f32 v88, 0.5, v88
    v_mul_f32 v88, v88, v21
    v_cvt_pk_bf16_f32 v21, v89, v89
    v_lshlrev_b32 v89, 16, v21
    v_add_f32 v89, v89, v37
    v_cvt_pk_bf16_f32 v21, v89, v89
    v_lshlrev_b32 v89, 16, v21
    v_mul_f32 v21, v89, v89
    v_fma_f32 v21, v21, s46, 1.0
    v_mul_f32 v21, v21, v89
    v_mul_f32 v21, s47, v21
    v_exp_f32 v21, v21
    s_nop 0
    v_add_f32 v21, 1.0, v21
    v_rcp_f32 v21, v21
    s_nop 0
    v_fma_f32 v21, v21, -2.0, 1.0
    v_add_f32 v21, 1.0, v21
    v_mul_f32 v89, 0.5, v89
    v_mul_f32 v89, v89, v21
    v_cvt_pk_bf16_f32 v21, v90, v90
    v_lshlrev_b32 v90, 16, v21
    v_add_f32 v90, v90, v38
    v_cvt_pk_bf16_f32 v21, v90, v90
    v_lshlrev_b32 v90, 16, v21
    v_mul_f32 v21, v90, v90
    v_fma_f32 v21, v21, s46, 1.0
    v_mul_f32 v21, v21, v90
    v_mul_f32 v21, s47, v21
    v_exp_f32 v21, v21
    s_nop 0
    v_add_f32 v21, 1.0, v21
    v_rcp_f32 v21, v21
    s_nop 0
    v_fma_f32 v21, v21, -2.0, 1.0
    v_add_f32 v21, 1.0, v21
    v_mul_f32 v90, 0.5, v90
    v_mul_f32 v90, v90, v21
    v_cvt_pk_bf16_f32 v21, v91, v91
    v_lshlrev_b32 v91, 16, v21
    v_add_f32 v91, v91, v39
    v_cvt_pk_bf16_f32 v21, v91, v91
    v_lshlrev_b32 v91, 16, v21
    v_mul_f32 v21, v91, v91
    v_fma_f32 v21, v21, s46, 1.0
    v_mul_f32 v21, v21, v91
    v_mul_f32 v21, s47, v21
    v_exp_f32 v21, v21
    s_nop 0
    v_add_f32 v21, 1.0, v21
    v_rcp_f32 v21, v21
    s_nop 0
    v_fma_f32 v21, v21, -2.0, 1.0
    v_add_f32 v21, 1.0, v21
    v_mul_f32 v91, 0.5, v91
    v_mul_f32 v91, v91, v21
    v_cvt_pk_bf16_f32 v22, v88, v89
    v_cvt_pk_bf16_f32 v23, v90, v91
    buffer_store_dwordx2 v[22:23], v19, s[8:11], s45 offen offset:32 sc1
    s_nop 1
    v_cvt_pk_bf16_f32 v21, v104, v104
    v_lshlrev_b32 v104, 16, v21
    v_add_f32 v104, v104, v40
    v_cvt_pk_bf16_f32 v21, v104, v104
    v_lshlrev_b32 v104, 16, v21
    v_mul_f32 v21, v104, v104
    v_fma_f32 v21, v21, s46, 1.0
    v_mul_f32 v21, v21, v104
    v_mul_f32 v21, s47, v21
    v_exp_f32 v21, v21
    s_nop 0
    v_add_f32 v21, 1.0, v21
    v_rcp_f32 v21, v21
    s_nop 0
    v_fma_f32 v21, v21, -2.0, 1.0
    v_add_f32 v21, 1.0, v21
    v_mul_f32 v104, 0.5, v104
    v_mul_f32 v104, v104, v21
    v_cvt_pk_bf16_f32 v21, v105, v105
    v_lshlrev_b32 v105, 16, v21
    v_add_f32 v105, v105, v41
    v_cvt_pk_bf16_f32 v21, v105, v105
    v_lshlrev_b32 v105, 16, v21
    v_mul_f32 v21, v105, v105
    v_fma_f32 v21, v21, s46, 1.0
    v_mul_f32 v21, v21, v105
    v_mul_f32 v21, s47, v21
    v_exp_f32 v21, v21
    s_nop 0
    v_add_f32 v21, 1.0, v21
    v_rcp_f32 v21, v21
    s_nop 0
    v_fma_f32 v21, v21, -2.0, 1.0
    v_add_f32 v21, 1.0, v21
    v_mul_f32 v105, 0.5, v105
    v_mul_f32 v105, v105, v21
    v_cvt_pk_bf16_f32 v21, v106, v106
    v_lshlrev_b32 v106, 16, v21
    v_add_f32 v106, v106, v42
    v_cvt_pk_bf16_f32 v21, v106, v106
    v_lshlrev_b32 v106, 16, v21
    v_mul_f32 v21, v106, v106
    v_fma_f32 v21, v21, s46, 1.0
    v_mul_f32 v21, v21, v106
    v_mul_f32 v21, s47, v21
    v_exp_f32 v21, v21
    s_nop 0
    v_add_f32 v21, 1.0, v21
    v_rcp_f32 v21, v21
    s_nop 0
    v_fma_f32 v21, v21, -2.0, 1.0
    v_add_f32 v21, 1.0, v21
    v_mul_f32 v106, 0.5, v106
    v_mul_f32 v106, v106, v21
    v_cvt_pk_bf16_f32 v21, v107, v107
    v_lshlrev_b32 v107, 16, v21
    v_add_f32 v107, v107, v43
    v_cvt_pk_bf16_f32 v21, v107, v107
    v_lshlrev_b32 v107, 16, v21
    v_mul_f32 v21, v107, v107
    v_fma_f32 v21, v21, s46, 1.0
    v_mul_f32 v21, v21, v107
    v_mul_f32 v21, s47, v21
    v_exp_f32 v21, v21
    s_nop 0
    v_add_f32 v21, 1.0, v21
    v_rcp_f32 v21, v21
    s_nop 0
    v_fma_f32 v21, v21, -2.0, 1.0
    v_add_f32 v21, 1.0, v21
    v_mul_f32 v107, 0.5, v107
    v_mul_f32 v107, v107, v21
    v_cvt_pk_bf16_f32 v22, v104, v105
    v_cvt_pk_bf16_f32 v23, v106, v107
    buffer_store_dwordx2 v[22:23], v19, s[8:11], s45 offen offset:64 sc1
    s_nop 1
    v_cvt_pk_bf16_f32 v21, v120, v120
    v_lshlrev_b32 v120, 16, v21
    v_add_f32 v120, v120, v44
    v_cvt_pk_bf16_f32 v21, v120, v120
    v_lshlrev_b32 v120, 16, v21
    v_mul_f32 v21, v120, v120
    v_fma_f32 v21, v21, s46, 1.0
    v_mul_f32 v21, v21, v120
    v_mul_f32 v21, s47, v21
    v_exp_f32 v21, v21
    s_nop 0
    v_add_f32 v21, 1.0, v21
    v_rcp_f32 v21, v21
    s_nop 0
    v_fma_f32 v21, v21, -2.0, 1.0
    v_add_f32 v21, 1.0, v21
    v_mul_f32 v120, 0.5, v120
    v_mul_f32 v120, v120, v21
    v_cvt_pk_bf16_f32 v21, v121, v121
    v_lshlrev_b32 v121, 16, v21
    v_add_f32 v121, v121, v45
    v_cvt_pk_bf16_f32 v21, v121, v121
    v_lshlrev_b32 v121, 16, v21
    v_mul_f32 v21, v121, v121
    v_fma_f32 v21, v21, s46, 1.0
    v_mul_f32 v21, v21, v121
    v_mul_f32 v21, s47, v21
    v_exp_f32 v21, v21
    s_nop 0
    v_add_f32 v21, 1.0, v21
    v_rcp_f32 v21, v21
    s_nop 0
    v_fma_f32 v21, v21, -2.0, 1.0
    v_add_f32 v21, 1.0, v21
    v_mul_f32 v121, 0.5, v121
    v_mul_f32 v121, v121, v21
    v_cvt_pk_bf16_f32 v21, v122, v122
    v_lshlrev_b32 v122, 16, v21
    v_add_f32 v122, v122, v46
    v_cvt_pk_bf16_f32 v21, v122, v122
    v_lshlrev_b32 v122, 16, v21
    v_mul_f32 v21, v122, v122
    v_fma_f32 v21, v21, s46, 1.0
    v_mul_f32 v21, v21, v122
    v_mul_f32 v21, s47, v21
    v_exp_f32 v21, v21
    s_nop 0
    v_add_f32 v21, 1.0, v21
    v_rcp_f32 v21, v21
    s_nop 0
    v_fma_f32 v21, v21, -2.0, 1.0
    v_add_f32 v21, 1.0, v21
    v_mul_f32 v122, 0.5, v122
    v_mul_f32 v122, v122, v21
    v_cvt_pk_bf16_f32 v21, v123, v123
    v_lshlrev_b32 v123, 16, v21
    v_add_f32 v123, v123, v47
    v_cvt_pk_bf16_f32 v21, v123, v123
    v_lshlrev_b32 v123, 16, v21
    v_mul_f32 v21, v123, v123
    v_fma_f32 v21, v21, s46, 1.0
    v_mul_f32 v21, v21, v123
    v_mul_f32 v21, s47, v21
    v_exp_f32 v21, v21
    s_nop 0
    v_add_f32 v21, 1.0, v21
    v_rcp_f32 v21, v21
    s_nop 0
    v_fma_f32 v21, v21, -2.0, 1.0
    v_add_f32 v21, 1.0, v21
    v_mul_f32 v123, 0.5, v123
    v_mul_f32 v123, v123, v21
    v_cvt_pk_bf16_f32 v22, v120, v121
    v_cvt_pk_bf16_f32 v23, v122, v123
    buffer_store_dwordx2 v[22:23], v19, s[8:11], s45 offen offset:96 sc1
    s_nop 1
    s_add_u32 s45, s45, s44
    v_cvt_pk_bf16_f32 v21, v76, v76
    v_lshlrev_b32 v76, 16, v21
    v_add_f32 v76, v76, v32
    v_cvt_pk_bf16_f32 v21, v76, v76
    v_lshlrev_b32 v76, 16, v21
    v_mul_f32 v21, v76, v76
    v_fma_f32 v21, v21, s46, 1.0
    v_mul_f32 v21, v21, v76
    v_mul_f32 v21, s47, v21
    v_exp_f32 v21, v21
    s_nop 0
    v_add_f32 v21, 1.0, v21
    v_rcp_f32 v21, v21
    s_nop 0
    v_fma_f32 v21, v21, -2.0, 1.0
    v_add_f32 v21, 1.0, v21
    v_mul_f32 v76, 0.5, v76
    v_mul_f32 v76, v76, v21
    v_cvt_pk_bf16_f32 v21, v77, v77
    v_lshlrev_b32 v77, 16, v21
    v_add_f32 v77, v77, v33
    v_cvt_pk_bf16_f32 v21, v77, v77
    v_lshlrev_b32 v77, 16, v21
    v_mul_f32 v21, v77, v77
    v_fma_f32 v21, v21, s46, 1.0
    v_mul_f32 v21, v21, v77
    v_mul_f32 v21, s47, v21
    v_exp_f32 v21, v21
    s_nop 0
    v_add_f32 v21, 1.0, v21
    v_rcp_f32 v21, v21
    s_nop 0
    v_fma_f32 v21, v21, -2.0, 1.0
    v_add_f32 v21, 1.0, v21
    v_mul_f32 v77, 0.5, v77
    v_mul_f32 v77, v77, v21
    v_cvt_pk_bf16_f32 v21, v78, v78
    v_lshlrev_b32 v78, 16, v21
    v_add_f32 v78, v78, v34
    v_cvt_pk_bf16_f32 v21, v78, v78
    v_lshlrev_b32 v78, 16, v21
    v_mul_f32 v21, v78, v78
    v_fma_f32 v21, v21, s46, 1.0
    v_mul_f32 v21, v21, v78
    v_mul_f32 v21, s47, v21
    v_exp_f32 v21, v21
    s_nop 0
    v_add_f32 v21, 1.0, v21
    v_rcp_f32 v21, v21
    s_nop 0
    v_fma_f32 v21, v21, -2.0, 1.0
    v_add_f32 v21, 1.0, v21
    v_mul_f32 v78, 0.5, v78
    v_mul_f32 v78, v78, v21
    v_cvt_pk_bf16_f32 v21, v79, v79
    v_lshlrev_b32 v79, 16, v21
    v_add_f32 v79, v79, v35
    v_cvt_pk_bf16_f32 v21, v79, v79
    v_lshlrev_b32 v79, 16, v21
    v_mul_f32 v21, v79, v79
    v_fma_f32 v21, v21, s46, 1.0
    v_mul_f32 v21, v21, v79
    v_mul_f32 v21, s47, v21
    v_exp_f32 v21, v21
    s_nop 0
    v_add_f32 v21, 1.0, v21
    v_rcp_f32 v21, v21
    s_nop 0
    v_fma_f32 v21, v21, -2.0, 1.0
    v_add_f32 v21, 1.0, v21
    v_mul_f32 v79, 0.5, v79
    v_mul_f32 v79, v79, v21
    v_cvt_pk_bf16_f32 v22, v76, v77
    v_cvt_pk_bf16_f32 v23, v78, v79
    buffer_store_dwordx2 v[22:23], v19, s[8:11], s45 offen offset:0 sc1
    s_nop 1
    v_cvt_pk_bf16_f32 v21, v92, v92
    v_lshlrev_b32 v92, 16, v21
    v_add_f32 v92, v92, v36
    v_cvt_pk_bf16_f32 v21, v92, v92
    v_lshlrev_b32 v92, 16, v21
    v_mul_f32 v21, v92, v92
    v_fma_f32 v21, v21, s46, 1.0
    v_mul_f32 v21, v21, v92
    v_mul_f32 v21, s47, v21
    v_exp_f32 v21, v21
    s_nop 0
    v_add_f32 v21, 1.0, v21
    v_rcp_f32 v21, v21
    s_nop 0
    v_fma_f32 v21, v21, -2.0, 1.0
    v_add_f32 v21, 1.0, v21
    v_mul_f32 v92, 0.5, v92
    v_mul_f32 v92, v92, v21
    v_cvt_pk_bf16_f32 v21, v93, v93
    v_lshlrev_b32 v93, 16, v21
    v_add_f32 v93, v93, v37
    v_cvt_pk_bf16_f32 v21, v93, v93
    v_lshlrev_b32 v93, 16, v21
    v_mul_f32 v21, v93, v93
    v_fma_f32 v21, v21, s46, 1.0
    v_mul_f32 v21, v21, v93
    v_mul_f32 v21, s47, v21
    v_exp_f32 v21, v21
    s_nop 0
    v_add_f32 v21, 1.0, v21
    v_rcp_f32 v21, v21
    s_nop 0
    v_fma_f32 v21, v21, -2.0, 1.0
    v_add_f32 v21, 1.0, v21
    v_mul_f32 v93, 0.5, v93
    v_mul_f32 v93, v93, v21
    v_cvt_pk_bf16_f32 v21, v94, v94
    v_lshlrev_b32 v94, 16, v21
    v_add_f32 v94, v94, v38
    v_cvt_pk_bf16_f32 v21, v94, v94
    v_lshlrev_b32 v94, 16, v21
    v_mul_f32 v21, v94, v94
    v_fma_f32 v21, v21, s46, 1.0
    v_mul_f32 v21, v21, v94
    v_mul_f32 v21, s47, v21
    v_exp_f32 v21, v21
    s_nop 0
    v_add_f32 v21, 1.0, v21
    v_rcp_f32 v21, v21
    s_nop 0
    v_fma_f32 v21, v21, -2.0, 1.0
    v_add_f32 v21, 1.0, v21
    v_mul_f32 v94, 0.5, v94
    v_mul_f32 v94, v94, v21
    v_cvt_pk_bf16_f32 v21, v95, v95
    v_lshlrev_b32 v95, 16, v21
    v_add_f32 v95, v95, v39
    v_cvt_pk_bf16_f32 v21, v95, v95
    v_lshlrev_b32 v95, 16, v21
    v_mul_f32 v21, v95, v95
    v_fma_f32 v21, v21, s46, 1.0
    v_mul_f32 v21, v21, v95
    v_mul_f32 v21, s47, v21
    v_exp_f32 v21, v21
    s_nop 0
    v_add_f32 v21, 1.0, v21
    v_rcp_f32 v21, v21
    s_nop 0
    v_fma_f32 v21, v21, -2.0, 1.0
    v_add_f32 v21, 1.0, v21
    v_mul_f32 v95, 0.5, v95
    v_mul_f32 v95, v95, v21
    v_cvt_pk_bf16_f32 v22, v92, v93
    v_cvt_pk_bf16_f32 v23, v94, v95
    buffer_store_dwordx2 v[22:23], v19, s[8:11], s45 offen offset:32 sc1
    s_nop 1
    v_cvt_pk_bf16_f32 v21, v108, v108
    v_lshlrev_b32 v108, 16, v21
    v_add_f32 v108, v108, v40
    v_cvt_pk_bf16_f32 v21, v108, v108
    v_lshlrev_b32 v108, 16, v21
    v_mul_f32 v21, v108, v108
    v_fma_f32 v21, v21, s46, 1.0
    v_mul_f32 v21, v21, v108
    v_mul_f32 v21, s47, v21
    v_exp_f32 v21, v21
    s_nop 0
    v_add_f32 v21, 1.0, v21
    v_rcp_f32 v21, v21
    s_nop 0
    v_fma_f32 v21, v21, -2.0, 1.0
    v_add_f32 v21, 1.0, v21
    v_mul_f32 v108, 0.5, v108
    v_mul_f32 v108, v108, v21
    v_cvt_pk_bf16_f32 v21, v109, v109
    v_lshlrev_b32 v109, 16, v21
    v_add_f32 v109, v109, v41
    v_cvt_pk_bf16_f32 v21, v109, v109
    v_lshlrev_b32 v109, 16, v21
    v_mul_f32 v21, v109, v109
    v_fma_f32 v21, v21, s46, 1.0
    v_mul_f32 v21, v21, v109
    v_mul_f32 v21, s47, v21
    v_exp_f32 v21, v21
    s_nop 0
    v_add_f32 v21, 1.0, v21
    v_rcp_f32 v21, v21
    s_nop 0
    v_fma_f32 v21, v21, -2.0, 1.0
    v_add_f32 v21, 1.0, v21
    v_mul_f32 v109, 0.5, v109
    v_mul_f32 v109, v109, v21
    v_cvt_pk_bf16_f32 v21, v110, v110
    v_lshlrev_b32 v110, 16, v21
    v_add_f32 v110, v110, v42
    v_cvt_pk_bf16_f32 v21, v110, v110
    v_lshlrev_b32 v110, 16, v21
    v_mul_f32 v21, v110, v110
    v_fma_f32 v21, v21, s46, 1.0
    v_mul_f32 v21, v21, v110
    v_mul_f32 v21, s47, v21
    v_exp_f32 v21, v21
    s_nop 0
    v_add_f32 v21, 1.0, v21
    v_rcp_f32 v21, v21
    s_nop 0
    v_fma_f32 v21, v21, -2.0, 1.0
    v_add_f32 v21, 1.0, v21
    v_mul_f32 v110, 0.5, v110
    v_mul_f32 v110, v110, v21
    v_cvt_pk_bf16_f32 v21, v111, v111
    v_lshlrev_b32 v111, 16, v21
    v_add_f32 v111, v111, v43
    v_cvt_pk_bf16_f32 v21, v111, v111
    v_lshlrev_b32 v111, 16, v21
    v_mul_f32 v21, v111, v111
    v_fma_f32 v21, v21, s46, 1.0
    v_mul_f32 v21, v21, v111
    v_mul_f32 v21, s47, v21
    v_exp_f32 v21, v21
    s_nop 0
    v_add_f32 v21, 1.0, v21
    v_rcp_f32 v21, v21
    s_nop 0
    v_fma_f32 v21, v21, -2.0, 1.0
    v_add_f32 v21, 1.0, v21
    v_mul_f32 v111, 0.5, v111
    v_mul_f32 v111, v111, v21
    v_cvt_pk_bf16_f32 v22, v108, v109
    v_cvt_pk_bf16_f32 v23, v110, v111
    buffer_store_dwordx2 v[22:23], v19, s[8:11], s45 offen offset:64 sc1
    s_nop 1
    v_cvt_pk_bf16_f32 v21, v124, v124
    v_lshlrev_b32 v124, 16, v21
    v_add_f32 v124, v124, v44
    v_cvt_pk_bf16_f32 v21, v124, v124
    v_lshlrev_b32 v124, 16, v21
    v_mul_f32 v21, v124, v124
    v_fma_f32 v21, v21, s46, 1.0
    v_mul_f32 v21, v21, v124
    v_mul_f32 v21, s47, v21
    v_exp_f32 v21, v21
    s_nop 0
    v_add_f32 v21, 1.0, v21
    v_rcp_f32 v21, v21
    s_nop 0
    v_fma_f32 v21, v21, -2.0, 1.0
    v_add_f32 v21, 1.0, v21
    v_mul_f32 v124, 0.5, v124
    v_mul_f32 v124, v124, v21
    v_cvt_pk_bf16_f32 v21, v125, v125
    v_lshlrev_b32 v125, 16, v21
    v_add_f32 v125, v125, v45
    v_cvt_pk_bf16_f32 v21, v125, v125
    v_lshlrev_b32 v125, 16, v21
    v_mul_f32 v21, v125, v125
    v_fma_f32 v21, v21, s46, 1.0
    v_mul_f32 v21, v21, v125
    v_mul_f32 v21, s47, v21
    v_exp_f32 v21, v21
    s_nop 0
    v_add_f32 v21, 1.0, v21
    v_rcp_f32 v21, v21
    s_nop 0
    v_fma_f32 v21, v21, -2.0, 1.0
    v_add_f32 v21, 1.0, v21
    v_mul_f32 v125, 0.5, v125
    v_mul_f32 v125, v125, v21
    v_cvt_pk_bf16_f32 v21, v126, v126
    v_lshlrev_b32 v126, 16, v21
    v_add_f32 v126, v126, v46
    v_cvt_pk_bf16_f32 v21, v126, v126
    v_lshlrev_b32 v126, 16, v21
    v_mul_f32 v21, v126, v126
    v_fma_f32 v21, v21, s46, 1.0
    v_mul_f32 v21, v21, v126
    v_mul_f32 v21, s47, v21
    v_exp_f32 v21, v21
    s_nop 0
    v_add_f32 v21, 1.0, v21
    v_rcp_f32 v21, v21
    s_nop 0
    v_fma_f32 v21, v21, -2.0, 1.0
    v_add_f32 v21, 1.0, v21
    v_mul_f32 v126, 0.5, v126
    v_mul_f32 v126, v126, v21
    v_cvt_pk_bf16_f32 v21, v127, v127
    v_lshlrev_b32 v127, 16, v21
    v_add_f32 v127, v127, v47
    v_cvt_pk_bf16_f32 v21, v127, v127
    v_lshlrev_b32 v127, 16, v21
    v_mul_f32 v21, v127, v127
    v_fma_f32 v21, v21, s46, 1.0
    v_mul_f32 v21, v21, v127
    v_mul_f32 v21, s47, v21
    v_exp_f32 v21, v21
    s_nop 0
    v_add_f32 v21, 1.0, v21
    v_rcp_f32 v21, v21
    s_nop 0
    v_fma_f32 v21, v21, -2.0, 1.0
    v_add_f32 v21, 1.0, v21
    v_mul_f32 v127, 0.5, v127
    v_mul_f32 v127, v127, v21
    v_cvt_pk_bf16_f32 v22, v124, v125
    v_cvt_pk_bf16_f32 v23, v126, v127
    buffer_store_dwordx2 v[22:23], v19, s[8:11], s45 offen offset:96 sc1
    s_nop 1
    s_add_u32 s45, s45, s44
    s_lshl_b32 s33, s30, 7
    s_add_u32 s33, s33, 103721088
wk_signal:
    s_waitcnt vmcnt(0)
    s_barrier
    v_cmp_eq_u32 vcc, 0, v0
    s_and_saveexec_b64 s[40:41], vcc
    v_mov_b32 v1, 1
    v_mov_b32 v2, 0
    buffer_atomic_add v1, v2, s[8:11], s33 offen
    s_mov_b64 exec, s[40:41]
    s_branch wk_next
wk_epi_m2:
    v_cvt_pk_bf16_f32 v21, v64, v64
    v_lshlrev_b32 v64, 16, v21
    v_add_f32 v64, v64, v32
    v_cvt_pk_bf16_f32 v21, v65, v65
    v_lshlrev_b32 v65, 16, v21
    v_add_f32 v65, v65, v33
    v_cvt_pk_bf16_f32 v21, v66, v66
    v_lshlrev_b32 v66, 16, v21
    v_add_f32 v66, v66, v34
    v_cvt_pk_bf16_f32 v21, v67, v67
    v_lshlrev_b32 v67, 16, v21
    v_add_f32 v67, v67, v35
    v_cvt_pk_bf16_f32 v22, v64, v65
    v_cvt_pk_bf16_f32 v23, v66, v67
    buffer_store_dwordx2 v[22:23], v19, s[8:11], s45 offen offset:0
    s_nop 1
    v_cvt_pk_bf16_f32 v21, v80, v80
    v_lshlrev_b32 v80, 16, v21
    v_add_f32 v80, v80, v36
    v_cvt_pk_bf16_f32 v21, v81, v81
    v_lshlrev_b32 v81, 16, v21
    v_add_f32 v81, v81, v37
    v_cvt_pk_bf16_f32 v21, v82, v82
    v_lshlrev_b32 v82, 16, v21
    v_add_f32 v82, v82, v38
    v_cvt_pk_bf16_f32 v21, v83, v83
    v_lshlrev_b32 v83, 16, v21
    v_add_f32 v83, v83, v39
    v_cvt_pk_bf16_f32 v22, v80, v81
    v_cvt_pk_bf16_f32 v23, v82, v83
    buffer_store_dwordx2 v[22:23], v19, s[8:11], s45 offen offset:32
    s_nop 1
    v_cvt_pk_bf16_f32 v21, v96, v96
    v_lshlrev_b32 v96, 16, v21
    v_add_f32 v96, v96, v40
    v_cvt_pk_bf16_f32 v21, v97, v97
    v_lshlrev_b32 v97, 16, v21
    v_add_f32 v97, v97, v41
    v_cvt_pk_bf16_f32 v21, v98, v98
    v_lshlrev_b32 v98, 16, v21
    v_add_f32 v98, v98, v42
    v_cvt_pk_bf16_f32 v21, v99, v99
    v_lshlrev_b32 v99, 16, v21
    v_add_f32 v99, v99, v43
    v_cvt_pk_bf16_f32 v22, v96, v97
    v_cvt_pk_bf16_f32 v23, v98, v99
    buffer_store_dwordx2 v[22:23], v19, s[8:11], s45 offen offset:64
    s_nop 1
    v_cvt_pk_bf16_f32 v21, v112, v112
    v_lshlrev_b32 v112, 16, v21
    v_add_f32 v112, v112, v44
    v_cvt_pk_bf16_f32 v21, v113, v113
    v_lshlrev_b32 v113, 16, v21
    v_add_f32 v113, v113, v45
    v_cvt_pk_bf16_f32 v21, v114, v114
    v_lshlrev_b32 v114, 16, v21
    v_add_f32 v114, v114, v46
    v_cvt_pk_bf16_f32 v21, v115, v115
    v_lshlrev_b32 v115, 16, v21
    v_add_f32 v115, v115, v47
    v_cvt_pk_bf16_f32 v22, v112, v113
    v_cvt_pk_bf16_f32 v23, v114, v115
    buffer_store_dwordx2 v[22:23], v19, s[8:11], s45 offen offset:96
    s_nop 1
    s_add_u32 s45, s45, s44
    v_cvt_pk_bf16_f32 v21, v68, v68
    v_lshlrev_b32 v68, 16, v21
    v_add_f32 v68, v68, v32
    v_cvt_pk_bf16_f32 v21, v69, v69
    v_lshlrev_b32 v69, 16, v21
    v_add_f32 v69, v69, v33
    v_cvt_pk_bf16_f32 v21, v70, v70
    v_lshlrev_b32 v70, 16, v21
    v_add_f32 v70, v70, v34
    v_cvt_pk_bf16_f32 v21, v71, v71
    v_lshlrev_b32 v71, 16, v21
    v_add_f32 v71, v71, v35
    v_cvt_pk_bf16_f32 v22, v68, v69
    v_cvt_pk_bf16_f32 v23, v70, v71
    buffer_store_dwordx2 v[22:23], v19, s[8:11], s45 offen offset:0
    s_nop 1
    v_cvt_pk_bf16_f32 v21, v84, v84
    v_lshlrev_b32 v84, 16, v21
    v_add_f32 v84, v84, v36
    v_cvt_pk_bf16_f32 v21, v85, v85
    v_lshlrev_b32 v85, 16, v21
    v_add_f32 v85, v85, v37
    v_cvt_pk_bf16_f32 v21, v86, v86
    v_lshlrev_b32 v86, 16, v21
    v_add_f32 v86, v86, v38
    v_cvt_pk_bf16_f32 v21, v87, v87
    v_lshlrev_b32 v87, 16, v21
    v_add_f32 v87, v87, v39
    v_cvt_pk_bf16_f32 v22, v84, v85
    v_cvt_pk_bf16_f32 v23, v86, v87
    buffer_store_dwordx2 v[22:23], v19, s[8:11], s45 offen offset:32
    s_nop 1
    v_cvt_pk_bf16_f32 v21, v100, v100
    v_lshlrev_b32 v100, 16, v21
    v_add_f32 v100, v100, v40
    v_cvt_pk_bf16_f32 v21, v101, v101
    v_lshlrev_b32 v101, 16, v21
    v_add_f32 v101, v101, v41
    v_cvt_pk_bf16_f32 v21, v102, v102
    v_lshlrev_b32 v102, 16, v21
    v_add_f32 v102, v102, v42
    v_cvt_pk_bf16_f32 v21, v103, v103
    v_lshlrev_b32 v103, 16, v21
    v_add_f32 v103, v103, v43
    v_cvt_pk_bf16_f32 v22, v100, v101
    v_cvt_pk_bf16_f32 v23, v102, v103
    buffer_store_dwordx2 v[22:23], v19, s[8:11], s45 offen offset:64
    s_nop 1
    v_cvt_pk_bf16_f32 v21, v116, v116
    v_lshlrev_b32 v116, 16, v21
    v_add_f32 v116, v116, v44
    v_cvt_pk_bf16_f32 v21, v117, v117
    v_lshlrev_b32 v117, 16, v21
    v_add_f32 v117, v117, v45
    v_cvt_pk_bf16_f32 v21, v118, v118
    v_lshlrev_b32 v118, 16, v21
    v_add_f32 v118, v118, v46
    v_cvt_pk_bf16_f32 v21, v119, v119
    v_lshlrev_b32 v119, 16, v21
    v_add_f32 v119, v119, v47
    v_cvt_pk_bf16_f32 v22, v116, v117
    v_cvt_pk_bf16_f32 v23, v118, v119
    buffer_store_dwordx2 v[22:23], v19, s[8:11], s45 offen offset:96
    s_nop 1
    s_add_u32 s45, s45, s44
    v_cvt_pk_bf16_f32 v21, v72, v72
    v_lshlrev_b32 v72, 16, v21
    v_add_f32 v72, v72, v32
    v_cvt_pk_bf16_f32 v21, v73, v73
    v_lshlrev_b32 v73, 16, v21
    v_add_f32 v73, v73, v33
    v_cvt_pk_bf16_f32 v21, v74, v74
    v_lshlrev_b32 v74, 16, v21
    v_add_f32 v74, v74, v34
    v_cvt_pk_bf16_f32 v21, v75, v75
    v_lshlrev_b32 v75, 16, v21
    v_add_f32 v75, v75, v35
    v_cvt_pk_bf16_f32 v22, v72, v73
    v_cvt_pk_bf16_f32 v23, v74, v75
    buffer_store_dwordx2 v[22:23], v19, s[8:11], s45 offen offset:0
    s_nop 1
    v_cvt_pk_bf16_f32 v21, v88, v88
    v_lshlrev_b32 v88, 16, v21
    v_add_f32 v88, v88, v36
    v_cvt_pk_bf16_f32 v21, v89, v89
    v_lshlrev_b32 v89, 16, v21
    v_add_f32 v89, v89, v37
    v_cvt_pk_bf16_f32 v21, v90, v90
    v_lshlrev_b32 v90, 16, v21
    v_add_f32 v90, v90, v38
    v_cvt_pk_bf16_f32 v21, v91, v91
    v_lshlrev_b32 v91, 16, v21
    v_add_f32 v91, v91, v39
    v_cvt_pk_bf16_f32 v22, v88, v89
    v_cvt_pk_bf16_f32 v23, v90, v91
    buffer_store_dwordx2 v[22:23], v19, s[8:11], s45 offen offset:32
    s_nop 1
    v_cvt_pk_bf16_f32 v21, v104, v104
    v_lshlrev_b32 v104, 16, v21
    v_add_f32 v104, v104, v40
    v_cvt_pk_bf16_f32 v21, v105, v105
    v_lshlrev_b32 v105, 16, v21
    v_add_f32 v105, v105, v41
    v_cvt_pk_bf16_f32 v21, v106, v106
    v_lshlrev_b32 v106, 16, v21
    v_add_f32 v106, v106, v42
    v_cvt_pk_bf16_f32 v21, v107, v107
    v_lshlrev_b32 v107, 16, v21
    v_add_f32 v107, v107, v43
    v_cvt_pk_bf16_f32 v22, v104, v105
    v_cvt_pk_bf16_f32 v23, v106, v107
    buffer_store_dwordx2 v[22:23], v19, s[8:11], s45 offen offset:64
    s_nop 1
    v_cvt_pk_bf16_f32 v21, v120, v120
    v_lshlrev_b32 v120, 16, v21
    v_add_f32 v120, v120, v44
    v_cvt_pk_bf16_f32 v21, v121, v121
    v_lshlrev_b32 v121, 16, v21
    v_add_f32 v121, v121, v45
    v_cvt_pk_bf16_f32 v21, v122, v122
    v_lshlrev_b32 v122, 16, v21
    v_add_f32 v122, v122, v46
    v_cvt_pk_bf16_f32 v21, v123, v123
    v_lshlrev_b32 v123, 16, v21
    v_add_f32 v123, v123, v47
    v_cvt_pk_bf16_f32 v22, v120, v121
    v_cvt_pk_bf16_f32 v23, v122, v123
    buffer_store_dwordx2 v[22:23], v19, s[8:11], s45 offen offset:96
    s_nop 1
    s_add_u32 s45, s45, s44
    v_cvt_pk_bf16_f32 v21, v76, v76
    v_lshlrev_b32 v76, 16, v21
    v_add_f32 v76, v76, v32
    v_cvt_pk_bf16_f32 v21, v77, v77
    v_lshlrev_b32 v77, 16, v21
    v_add_f32 v77, v77, v33
    v_cvt_pk_bf16_f32 v21, v78, v78
    v_lshlrev_b32 v78, 16, v21
    v_add_f32 v78, v78, v34
    v_cvt_pk_bf16_f32 v21, v79, v79
    v_lshlrev_b32 v79, 16, v21
    v_add_f32 v79, v79, v35
    v_cvt_pk_bf16_f32 v22, v76, v77
    v_cvt_pk_bf16_f32 v23, v78, v79
    buffer_store_dwordx2 v[22:23], v19, s[8:11], s45 offen offset:0
    s_nop 1
    v_cvt_pk_bf16_f32 v21, v92, v92
    v_lshlrev_b32 v92, 16, v21
    v_add_f32 v92, v92, v36
    v_cvt_pk_bf16_f32 v21, v93, v93
    v_lshlrev_b32 v93, 16, v21
    v_add_f32 v93, v93, v37
    v_cvt_pk_bf16_f32 v21, v94, v94
    v_lshlrev_b32 v94, 16, v21
    v_add_f32 v94, v94, v38
    v_cvt_pk_bf16_f32 v21, v95, v95
    v_lshlrev_b32 v95, 16, v21
    v_add_f32 v95, v95, v39
    v_cvt_pk_bf16_f32 v22, v92, v93
    v_cvt_pk_bf16_f32 v23, v94, v95
    buffer_store_dwordx2 v[22:23], v19, s[8:11], s45 offen offset:32
    s_nop 1
    v_cvt_pk_bf16_f32 v21, v108, v108
    v_lshlrev_b32 v108, 16, v21
    v_add_f32 v108, v108, v40
    v_cvt_pk_bf16_f32 v21, v109, v109
    v_lshlrev_b32 v109, 16, v21
    v_add_f32 v109, v109, v41
    v_cvt_pk_bf16_f32 v21, v110, v110
    v_lshlrev_b32 v110, 16, v21
    v_add_f32 v110, v110, v42
    v_cvt_pk_bf16_f32 v21, v111, v111
    v_lshlrev_b32 v111, 16, v21
    v_add_f32 v111, v111, v43
    v_cvt_pk_bf16_f32 v22, v108, v109
    v_cvt_pk_bf16_f32 v23, v110, v111
    buffer_store_dwordx2 v[22:23], v19, s[8:11], s45 offen offset:64
    s_nop 1
    v_cvt_pk_bf16_f32 v21, v124, v124
    v_lshlrev_b32 v124, 16, v21
    v_add_f32 v124, v124, v44
    v_cvt_pk_bf16_f32 v21, v125, v125
    v_lshlrev_b32 v125, 16, v21
    v_add_f32 v125, v125, v45
    v_cvt_pk_bf16_f32 v21, v126, v126
    v_lshlrev_b32 v126, 16, v21
    v_add_f32 v126, v126, v46
    v_cvt_pk_bf16_f32 v21, v127, v127
    v_lshlrev_b32 v127, 16, v21
    v_add_f32 v127, v127, v47
    v_cvt_pk_bf16_f32 v22, v124, v125
    v_cvt_pk_bf16_f32 v23, v126, v127
    buffer_store_dwordx2 v[22:23], v19, s[8:11], s45 offen offset:96
    s_nop 1
    s_add_u32 s45, s45, s44
    s_branch wk_next
wk_kv0:
    v_lshrrev_b32 v1, 3, v0
    v_and_b32 v2, 7, v0
    v_mul_u32_u24 v12, 160, v1
    v_lshl_add_u32 v12, v2, 4, v12
    v_lshrrev_b32 v1, 3, v0
    v_and_b32 v2, 7, v0
    v_mul_u32_u24 v13, 160, v1
    v_lshl_add_u32 v13, v2, 4, v13
    v_add_u32 v13, 40960, v13
    v_lshrrev_b32 v1, 6, v0
    v_and_b32 v2, 3, v1
    v_lshrrev_b32 v3, 2, v1
    v_and_b32 v16, 63, v0
    v_and_b32 v17, 15, v16
    v_lshrrev_b32 v18, 4, v16
    v_lshl_add_u32 v19, v2, 6, v17
    v_mul_u32_u24 v14, 160, v19
    v_lshl_add_u32 v14, v18, 4, v14
    v_lshrrev_b32 v19, 2, v17
    v_lshl_add_u32 v19, v18, 3, v19
    v_mul_u32_u24 v15, 160, v19
    v_and_b32 v19, 3, v17
    v_lshlrev_b32 v19, 2, v19
    v_lshl_add_u32 v19, v3, 5, v19
    v_lshl_add_u32 v15, v19, 1, v15
    v_add_u32 v15, 40960, v15
    v_add_u32 v224, 51200, v12
    v_add_u32 v225, 51200, v13
    v_add_u32 v226, 51200, v14
    v_add_u32 v227, 51200, v15
    s_mov_b32 s12, s50
    s_mov_b32 s13, s51
    s_cmp_ge_u32 s60, 64
    s_cselect_b32 s12, s52, s12
    s_cselect_b32 s13, s53, s13
    s_mov_b32 s14, 8388608
    s_and_b32 s34, s60, 63
    s_lshl_b32 s34, s34, 7
    s_mov_b32 s35, 2048
    s_mov_b32 s36, 8192
    s_mov_b32 s37, 0
    s_mov_b32 s30, 0
    s_mov_b32 s32, 0
    s_mov_b32 s38, 0
    v_lshrrev_b32 v1, 3, v0
    v_and_b32 v2, 7, v0
    v_add_u32 v1, s32, v1
    v_add_u32 v3, 0, v1
    v_mul_lo_u32 v3, v3, s35
    v_lshl_add_u32 v4, v2, 4, v3
    v_add_u32 v3, 64, v1
    v_mul_lo_u32 v3, v3, s35
    v_lshl_add_u32 v5, v2, 4, v3
    v_add_u32 v3, 128, v1
    v_mul_lo_u32 v3, v3, s35
    v_lshl_add_u32 v6, v2, 4, v3
    v_add_u32 v3, 192, v1
    v_mul_lo_u32 v3, v3, s35
    v_lshl_add_u32 v7, v2, 4, v3
    v_lshrrev_b32 v1, 3, v0
    v_and_b32 v2, 7, v0
    v_add_u32 v3, 0, v1
    v_mul_lo_u32 v3, v3, s36
    v_lshl_add_u32 v3, v2, 4, v3
    v_add_u32 v8, s34, v3
    v_mov_b32 v64, 0
    v_mov_b32 v65, 0
    v_mov_b32 v66, 0
    v_mov_b32 v67, 0
    v_mov_b32 v68, 0
    v_mov_b32 v69, 0
    v_mov_b32 v70, 0
    v_mov_b32 v71, 0
    v_mov_b32 v72, 0
    v_mov_b32 v73, 0
    v_mov_b32 v74, 0
    v_mov_b32 v75, 0
    v_mov_b32 v76, 0
    v_mov_b32 v77, 0
    v_mov_b32 v78, 0
    v_mov_b32 v79, 0
    v_mov_b32 v80, 0
    v_mov_b32 v81, 0
    v_mov_b32 v82, 0
    v_mov_b32 v83, 0
    v_mov_b32 v84, 0
    v_mov_b32 v85, 0
    v_mov_b32 v86, 0
    v_mov_b32 v87, 0
    v_mov_b32 v88, 0
    v_mov_b32 v89, 0
    v_mov_b32 v90, 0
    v_mov_b32 v91, 0
    v_mov_b32 v92, 0
    v_mov_b32 v93, 0
    v_mov_b32 v94, 0
    v_mov_b32 v95, 0
    v_mov_b32 v96, 0
    v_mov_b32 v97, 0
    v_mov_b32 v98, 0
    v_mov_b32 v99, 0
    v_mov_b32 v100, 0
    v_mov_b32 v101, 0
    v_mov_b32 v102, 0
    v_mov_b32 v103, 0
    v_mov_b32 v104, 0
    v_mov_b32 v105, 0
    v_mov_b32 v106, 0
    v_mov_b32 v107, 0
    v_mov_b32 v108, 0
    v_mov_b32 v109, 0
    v_mov_b32 v110, 0
    v_mov_b32 v111, 0
    v_mov_b32 v112, 0
    v_mov_b32 v113, 0
    v_mov_b32 v114, 0
    v_mov_b32 v115, 0
    v_mov_b32 v116, 0
    v_mov_b32 v117, 0
    v_mov_b32 v118, 0
    v_mov_b32 v119, 0
    v_mov_b32 v120, 0
    v_mov_b32 v121, 0
    v_mov_b32 v122, 0
    v_mov_b32 v123, 0
    v_mov_b32 v124, 0
    v_mov_b32 v125, 0
    v_mov_b32 v126, 0
    v_mov_b32 v127, 0
    buffer_load_dwordx4 v[128:131], v4, s[8:11], s37 offen
    buffer_load_dwordx4 v[132:135], v5, s[8:11], s37 offen
    buffer_load_dwordx4 v[136:139], v6, s[8:11], s37 offen
    buffer_load_dwordx4 v[140:143], v7, s[8:11], s37 offen
    buffer_load_dwordx4 v[144:147], v8, s[12:15], s38 offen
    s_add_u32 s37, s37, 128
    s_add_u32 s38, s38, 524288
    buffer_load_dwordx4 v[228:231], v4, s[8:11], s37 offen
    buffer_load_dwordx4 v[232:235], v5, s[8:11], s37 offen
    buffer_load_dwordx4 v[236:239], v6, s[8:11], s37 offen
    buffer_load_dwordx4 v[240:243], v7, s[8:11], s37 offen
    buffer_load_dwordx4 v[244:247], v8, s[12:15], s38 offen
    s_waitcnt vmcnt(5)
    ds_write_b128 v12, v[128:131] offset:0
    ds_write_b128 v12, v[132:135] offset:10240
    ds_write_b128 v12, v[136:139] offset:20480
    ds_write_b128 v12, v[140:143] offset:30720
    ds_write_b128 v13, v[144:147] offset:0
    s_waitcnt lgkmcnt(0)
    s_barrier
    s_mov_b32 s43, 8
gk_8:
    s_cmp_eq_u32 s43, 1
    s_cbranch_scc1 gl_9a
    s_add_u32 s37, s37, 128
    s_add_u32 s38, s38, 524288
    buffer_load_dwordx4 v[128:131], v4, s[8:11], s37 offen
    buffer_load_dwordx4 v[132:135], v5, s[8:11], s37 offen
    buffer_load_dwordx4 v[136:139], v6, s[8:11], s37 offen
    buffer_load_dwordx4 v[140:143], v7, s[8:11], s37 offen
    buffer_load_dwordx4 v[144:147], v8, s[12:15], s38 offen
gl_9a:
    ds_read_b64_tr_b16 v[160:161], v15 offset:0
    ds_read_b64_tr_b16 v[162:163], v15 offset:640
    ds_read_b64_tr_b16 v[164:165], v15 offset:32
    ds_read_b64_tr_b16 v[166:167], v15 offset:672
    ds_read_b128 v[192:195], v14 offset:0
    ds_read_b128 v[196:199], v14 offset:2560
    ds_read_b128 v[200:203], v14 offset:5120
    ds_read_b128 v[204:207], v14 offset:7680
    ds_read_b64_tr_b16 v[176:177], v15 offset:5120
    ds_read_b64_tr_b16 v[178:179], v15 offset:5760
    ds_read_b64_tr_b16 v[180:181], v15 offset:5152
    ds_read_b64_tr_b16 v[182:183], v15 offset:5792
    ds_read_b128 v[208:211], v14 offset:64
    ds_read_b128 v[212:215], v14 offset:2624
    ds_read_b128 v[216:219], v14 offset:5184
    ds_read_b128 v[220:223], v14 offset:7744
    s_waitcnt lgkmcnt(8)
    v_mfma_f32_16x16x32_bf16 v[64:67], v[160:163], v[192:195], v[64:67]
    v_mfma_f32_16x16x32_bf16 v[68:71], v[160:163], v[196:199], v[68:71]
    v_mfma_f32_16x16x32_bf16 v[72:75], v[160:163], v[200:203], v[72:75]
    v_mfma_f32_16x16x32_bf16 v[76:79], v[160:163], v[204:207], v[76:79]
    v_mfma_f32_16x16x32_bf16 v[80:83], v[164:167], v[192:195], v[80:83]
    v_mfma_f32_16x16x32_bf16 v[84:87], v[164:167], v[196:199], v[84:87]
    v_mfma_f32_16x16x32_bf16 v[88:91], v[164:167], v[200:203], v[88:91]
    v_mfma_f32_16x16x32_bf16 v[92:95], v[164:167], v[204:207], v[92:95]
    s_waitcnt lgkmcnt(0)
    v_mfma_f32_16x16x32_bf16 v[64:67], v[176:179], v[208:211], v[64:67]
    v_mfma_f32_16x16x32_bf16 v[68:71], v[176:179], v[212:215], v[68:71]
    v_mfma_f32_16x16x32_bf16 v[72:75], v[176:179], v[216:219], v[72:75]
    v_mfma_f32_16x16x32_bf16 v[76:79], v[176:179], v[220:223], v[76:79]
    v_mfma_f32_16x16x32_bf16 v[80:83], v[180:183], v[208:211], v[80:83]
    v_mfma_f32_16x16x32_bf16 v[84:87], v[180:183], v[212:215], v[84:87]
    v_mfma_f32_16x16x32_bf16 v[88:91], v[180:183], v[216:219], v[88:91]
    v_mfma_f32_16x16x32_bf16 v[92:95], v[180:183], v[220:223], v[92:95]
    s_cmp_eq_u32 s43, 1
    s_cbranch_scc1 gl_9b
    s_waitcnt vmcnt(5)
    ds_write_b128 v224, v[228:231] offset:0
    ds_write_b128 v224, v[232:235] offset:10240
    ds_write_b128 v224, v[236:239] offset:20480
    ds_write_b128 v224, v[240:243] offset:30720
    ds_write_b128 v225, v[244:247] offset:0
    s_waitcnt lgkmcnt(0)
    s_branch gl_9c
gl_9b:
    s_waitcnt vmcnt(0)
    ds_write_b128 v224, v[228:231] offset:0
    ds_write_b128 v224, v[232:235] offset:10240
    ds_write_b128 v224, v[236:239] offset:20480
    ds_write_b128 v224, v[240:243] offset:30720
    ds_write_b128 v225, v[244:247] offset:0
    s_waitcnt lgkmcnt(0)
gl_9c:
    s_barrier
    s_cmp_eq_u32 s43, 1
    s_cbranch_scc1 gl_10a
    s_add_u32 s37, s37, 128
    s_add_u32 s38, s38, 524288
    buffer_load_dwordx4 v[228:231], v4, s[8:11], s37 offen
    buffer_load_dwordx4 v[232:235], v5, s[8:11], s37 offen
    buffer_load_dwordx4 v[236:239], v6, s[8:11], s37 offen
    buffer_load_dwordx4 v[240:243], v7, s[8:11], s37 offen
    buffer_load_dwordx4 v[244:247], v8, s[12:15], s38 offen
gl_10a:
    ds_read_b64_tr_b16 v[160:161], v227 offset:0
    ds_read_b64_tr_b16 v[162:163], v227 offset:640
    ds_read_b64_tr_b16 v[164:165], v227 offset:32
    ds_read_b64_tr_b16 v[166:167], v227 offset:672
    ds_read_b128 v[192:195], v226 offset:0
    ds_read_b128 v[196:199], v226 offset:2560
    ds_read_b128 v[200:203], v226 offset:5120
    ds_read_b128 v[204:207], v226 offset:7680
    ds_read_b64_tr_b16 v[176:177], v227 offset:5120
    ds_read_b64_tr_b16 v[178:179], v227 offset:5760
    ds_read_b64_tr_b16 v[180:181], v227 offset:5152
    ds_read_b64_tr_b16 v[182:183], v227 offset:5792
    ds_read_b128 v[208:211], v226 offset:64
    ds_read_b128 v[212:215], v226 offset:2624
    ds_read_b128 v[216:219], v226 offset:5184
    ds_read_b128 v[220:223], v226 offset:7744
    s_waitcnt lgkmcnt(8)
    v_mfma_f32_16x16x32_bf16 v[64:67], v[160:163], v[192:195], v[64:67]
    v_mfma_f32_16x16x32_bf16 v[68:71], v[160:163], v[196:199], v[68:71]
    v_mfma_f32_16x16x32_bf16 v[72:75], v[160:163], v[200:203], v[72:75]
    v_mfma_f32_16x16x32_bf16 v[76:79], v[160:163], v[204:207], v[76:79]
    v_mfma_f32_16x16x32_bf16 v[80:83], v[164:167], v[192:195], v[80:83]
    v_mfma_f32_16x16x32_bf16 v[84:87], v[164:167], v[196:199], v[84:87]
    v_mfma_f32_16x16x32_bf16 v[88:91], v[164:167], v[200:203], v[88:91]
    v_mfma_f32_16x16x32_bf16 v[92:95], v[164:167], v[204:207], v[92:95]
    s_waitcnt lgkmcnt(0)
    v_mfma_f32_16x16x32_bf16 v[64:67], v[176:179], v[208:211], v[64:67]
    v_mfma_f32_16x16x32_bf16 v[68:71], v[176:179], v[212:215], v[68:71]
    v_mfma_f32_16x16x32_bf16 v[72:75], v[176:179], v[216:219], v[72:75]
    v_mfma_f32_16x16x32_bf16 v[76:79], v[176:179], v[220:223], v[76:79]
    v_mfma_f32_16x16x32_bf16 v[80:83], v[180:183], v[208:211], v[80:83]
    v_mfma_f32_16x16x32_bf16 v[84:87], v[180:183], v[212:215], v[84:87]
    v_mfma_f32_16x16x32_bf16 v[88:91], v[180:183], v[216:219], v[88:91]
    v_mfma_f32_16x16x32_bf16 v[92:95], v[180:183], v[220:223], v[92:95]
    s_cmp_eq_u32 s43, 1
    s_cbranch_scc1 gl_10b
    s_waitcnt vmcnt(5)
    ds_write_b128 v12, v[128:131] offset:0
    ds_write_b128 v12, v[132:135] offset:10240
    ds_write_b128 v12, v[136:139] offset:20480
    ds_write_b128 v12, v[140:143] offset:30720
    ds_write_b128 v13, v[144:147] offset:0
    s_waitcnt lgkmcnt(0)
    s_branch gl_10c
gl_10b:
gl_10c:
    s_barrier
    s_sub_u32 s43, s43, 1
    s_cmp_lg_u32 s43, 0
    s_cbranch_scc1 gk_8
    s_nop 7
    s_nop 7
    v_lshrrev_b32 v1, 6, v0
    v_and_b32 v2, 3, v1
    v_lshrrev_b32 v3, 2, v1
    v_and_b32 v16, 63, v0
    v_and_b32 v17, 15, v16
    v_lshrrev_b32 v18, 4, v16
    v_lshl_add_u32 v19, v2, 6, v17
    v_mul_u32_u24 v19, 24576, v19
    v_lshlrev_b32 v20, 2, v18
    v_lshl_add_u32 v20, v3, 5, v20
    v_lshl_add_u32 v19, v20, 1, v19
    s_lshl_b32 s45, s60, 7
    s_add_u32 s45, s45, 8396800
    v_cvt_pk_bf16_f32 v22, v64, v65
    v_cvt_pk_bf16_f32 v23, v66, v67
    buffer_store_dwordx2 v[22:23], v19, s[8:11], s45 offen offset:0 sc1
    v_cvt_pk_bf16_f32 v24, v80, v81
    v_cvt_pk_bf16_f32 v25, v82, v83
    buffer_store_dwordx2 v[24:25], v19, s[8:11], s45 offen offset:32 sc1
    s_add_u32 s45, s45, 393216
    s_nop 0
    v_cvt_pk_bf16_f32 v22, v68, v69
    v_cvt_pk_bf16_f32 v23, v70, v71
    buffer_store_dwordx2 v[22:23], v19, s[8:11], s45 offen offset:0 sc1
    v_cvt_pk_bf16_f32 v24, v84, v85
    v_cvt_pk_bf16_f32 v25, v86, v87
    buffer_store_dwordx2 v[24:25], v19, s[8:11], s45 offen offset:32 sc1
    s_add_u32 s45, s45, 393216
    s_nop 0
    v_cvt_pk_bf16_f32 v22, v72, v73
    v_cvt_pk_bf16_f32 v23, v74, v75
    buffer_store_dwordx2 v[22:23], v19, s[8:11], s45 offen offset:0 sc1
    v_cvt_pk_bf16_f32 v24, v88, v89
    v_cvt_pk_bf16_f32 v25, v90, v91
    buffer_store_dwordx2 v[24:25], v19, s[8:11], s45 offen offset:32 sc1
    s_add_u32 s45, s45, 393216
    s_nop 0
    v_cvt_pk_bf16_f32 v22, v76, v77
    v_cvt_pk_bf16_f32 v23, v78, v79
    buffer_store_dwordx2 v[22:23], v19, s[8:11], s45 offen offset:0 sc1
    v_cvt_pk_bf16_f32 v24, v92, v93
    v_cvt_pk_bf16_f32 v25, v94, v95
    buffer_store_dwordx2 v[24:25], v19, s[8:11], s45 offen offset:32 sc1
    s_add_u32 s45, s45, 393216
    s_nop 0
    s_mov_b32 s33, 103719040
    s_branch wk_signal
wk_done:
    s_endpgm
.globl attn_kernel
.p2align 8
.type attn_kernel,@function
attn_kernel:
    s_cmp_ge_u32 s2, 512
    s_cbranch_scc1 at_done
    s_load_dwordx2 s[8:9], s[0:1], 112
    s_mov_b32 s10, 268435456
    s_mov_b32 s11, 0x00020000
    v_and_b32 v1, 63, v0
    v_lshrrev_b32 v2, 6, v0
    v_and_b32 v3, 15, v1
    v_lshrrev_b32 v4, 4, v1
    s_nop 0
    v_readfirstlane_b32 s12, v2
    s_lshl_b32 s13, s2, 2
    s_add_u32 s13, s13, s12
    s_lshr_b32 s14, s13, 5
    s_and_b32 s15, s13, 31
    s_mul_i32 s16, s14, 786432
    s_lshl_b32 s17, s15, 8
    s_add_u32 s16, s16, s17
    s_add_u32 s16, s16, 8388608
    s_lshl_b32 s18, s13, 12
    s_add_u32 s18, s18, 92274688
    s_mul_i32 s19, s12, 13824
    s_waitcnt lgkmcnt(0)
    v_mul_u32_u24 v5, 24576, v3
    v_lshl_add_u32 v5, v4, 4, v5
    v_add_u32 v5, s16, v5
    v_add_u32 v6, 393216, v5
    buffer_load_dwordx4 v[16:19], v5, s[8:11], 0 offen offset:0
    buffer_load_dwordx4 v[32:35], v6, s[8:11], 0 offen offset:0
    buffer_load_dwordx4 v[20:23], v5, s[8:11], 0 offen offset:64
    buffer_load_dwordx4 v[36:39], v6, s[8:11], 0 offen offset:64
    buffer_load_dwordx4 v[24:27], v5, s[8:11], 0 offen offset:128
    buffer_load_dwordx4 v[40:43], v6, s[8:11], 0 offen offset:128
    buffer_load_dwordx4 v[28:31], v5, s[8:11], 0 offen offset:192
    buffer_load_dwordx4 v[44:47], v6, s[8:11], 0 offen offset:192
    v_add_u32 v7, 0, v3
    v_min_u32 v8, 39, v7
    v_subrev_u32 v8, 8, v8
    v_mul_u32_u24 v8, 24576, v8
    v_add_u32 v8, s16, v8
    v_add_u32 v8, 8192, v8
    v_lshlrev_b32 v9, 8, v7
    v_add_u32 v9, s18, v9
    v_cmp_gt_u32 vcc, 8, v7
    s_nop 1
    v_cndmask_b32 v8, v8, v9, vcc
    v_lshl_add_u32 v8, v4, 4, v8
    buffer_load_dwordx4 v[48:51], v8, s[8:11], 0 offen offset:0
    buffer_load_dwordx4 v[52:55], v8, s[8:11], 0 offen offset:64
    buffer_load_dwordx4 v[56:59], v8, s[8:11], 0 offen offset:128
    buffer_load_dwordx4 v[60:63], v8, s[8:11], 0 offen offset:192
    v_add_u32 v7, 16, v3
    v_min_u32 v8, 39, v7
    v_subrev_u32 v8, 8, v8
    v_mul_u32_u24 v8, 24576, v8
    v_add_u32 v8, s16, v8
    v_add_u32 v8, 8192, v8
    v_lshlrev_b32 v9, 8, v7
    v_add_u32 v9, s18, v9
    v_cmp_gt_u32 vcc, 8, v7
    s_nop 1
    v_cndmask_b32 v8, v8, v9, vcc
    v_lshl_add_u32 v8, v4, 4, v8
    buffer_load_dwordx4 v[64:67], v8, s[8:11], 0 offen offset:0
    buffer_load_dwordx4 v[68:71], v8, s[8:11], 0 offen offset:64
    buffer_load_dwordx4 v[72:75], v8, s[8:11], 0 offen offset:128
    buffer_load_dwordx4 v[76:79], v8, s[8:11], 0 offen offset:192
    v_add_u32 v7, 32, v3
    v_min_u32 v8, 39, v7
    v_subrev_u32 v8, 8, v8
    v_mul_u32_u24 v8, 24576, v8
    v_add_u32 v8, s16, v8
    v_add_u32 v8, 8192, v8
    v_lshlrev_b32 v9, 8, v7
    v_add_u32 v9, s18, v9
    v_cmp_gt_u32 vcc, 8, v7
    s_nop 1
    v_cndmask_b32 v8, v8, v9, vcc
    v_lshl_add_u32 v8, v4, 4, v8
    buffer_load_dwordx4 v[80:83], v8, s[8:11], 0 offen offset:0
    buffer_load_dwordx4 v[84:87], v8, s[8:11], 0 offen offset:64
    buffer_load_dwordx4 v[88:91], v8, s[8:11], 0 offen offset:128
    buffer_load_dwordx4 v[92:95], v8, s[8:11], 0 offen offset:192
    v_add_u32 v7, 0, v4
    v_subrev_u32 v8, 8, v7
    v_mul_u32_u24 v8, 24576, v8
    v_add_u32 v8, s16, v8
    v_add_u32 v8, 16384, v8
    v_lshlrev_b32 v9, 8, v7
    v_add_u32 v9, s18, v9
    v_add_u32 v9, 2048, v9
    v_cmp_gt_u32 vcc, 8, v7
    s_nop 1
    v_cndmask_b32 v8, v8, v9, vcc
    v_lshl_add_u32 v8, v3, 4, v8
    buffer_load_dwordx4 v[96:99], v8, s[8:11], 0 offen
    v_add_u32 v7, 4, v4
    v_subrev_u32 v8, 8, v7
    v_mul_u32_u24 v8, 24576, v8
    v_add_u32 v8, s16, v8
    v_add_u32 v8, 16384, v8
    v_lshlrev_b32 v9, 8, v7
    v_add_u32 v9, s18, v9
    v_add_u32 v9, 2048, v9
    v_cmp_gt_u32 vcc, 8, v7
    s_nop 1
    v_cndmask_b32 v8, v8, v9, vcc
    v_lshl_add_u32 v8, v3, 4, v8
    buffer_load_dwordx4 v[100:103], v8, s[8:11], 0 offen
    v_add_u32 v7, 8, v4
    v_subrev_u32 v8, 8, v7
    v_mul_u32_u24 v8, 24576, v8
    v_add_u32 v8, s16, v8
    v_add_u32 v8, 16384, v8
    v_lshlrev_b32 v9, 8, v7
    v_add_u32 v9, s18, v9
    v_add_u32 v9, 2048, v9
    v_cmp_gt_u32 vcc, 8, v7
    s_nop 1
    v_cndmask_b32 v8, v8, v9, vcc
    v_lshl_add_u32 v8, v3, 4, v8
    buffer_load_dwordx4 v[104:107], v8, s[8:11], 0 offen
    v_add_u32 v7, 12, v4
    v_subrev_u32 v8, 8, v7
    v_mul_u32_u24 v8, 24576, v8
    v_add_u32 v8, s16, v8
    v_add_u32 v8, 16384, v8
    v_lshlrev_b32 v9, 8, v7
    v_add_u32 v9, s18, v9
    v_add_u32 v9, 2048, v9
    v_cmp_gt_u32 vcc, 8, v7
    s_nop 1
    v_cndmask_b32 v8, v8, v9, vcc
    v_lshl_add_u32 v8, v3, 4, v8
    buffer_load_dwordx4 v[108:111], v8, s[8:11], 0 offen
    v_add_u32 v7, 16, v4
    v_subrev_u32 v8, 8, v7
    v_mul_u32_u24 v8, 24576, v8
    v_add_u32 v8, s16, v8
    v_add_u32 v8, 16384, v8
    v_lshlrev_b32 v9, 8, v7
    v_add_u32 v9, s18, v9
    v_add_u32 v9, 2048, v9
    v_cmp_gt_u32 vcc, 8, v7
    s_nop 1
    v_cndmask_b32 v8, v8, v9, vcc
    v_lshl_add_u32 v8, v3, 4, v8
    buffer_load_dwordx4 v[112:115], v8, s[8:11], 0 offen
    v_add_u32 v7, 20, v4
    v_subrev_u32 v8, 8, v7
    v_mul_u32_u24 v8, 24576, v8
    v_add_u32 v8, s16, v8
    v_add_u32 v8, 16384, v8
    v_lshlrev_b32 v9, 8, v7
    v_add_u32 v9, s18, v9
    v_add_u32 v9, 2048, v9
    v_cmp_gt_u32 vcc, 8, v7
    s_nop 1
    v_cndmask_b32 v8, v8, v9, vcc
    v_lshl_add_u32 v8, v3, 4, v8
    buffer_load_dwordx4 v[116:119], v8, s[8:11], 0 offen
    v_add_u32 v7, 24, v4
    v_subrev_u32 v8, 8, v7
    v_mul_u32_u24 v8, 24576, v8
    v_add_u32 v8, s16, v8
    v_add_u32 v8, 16384, v8
    v_lshlrev_b32 v9, 8, v7
    v_add_u32 v9, s18, v9
    v_add_u32 v9, 2048, v9
    v_cmp_gt_u32 vcc, 8, v7
    s_nop 1
    v_cndmask_b32 v8, v8, v9, vcc
    v_lshl_add_u32 v8, v3, 4, v8
    buffer_load_dwordx4 v[120:123], v8, s[8:11], 0 offen
    v_add_u32 v7, 28, v4
    v_subrev_u32 v8, 8, v7
    v_mul_u32_u24 v8, 24576, v8
    v_add_u32 v8, s16, v8
    v_add_u32 v8, 16384, v8
    v_lshlrev_b32 v9, 8, v7
    v_add_u32 v9, s18, v9
    v_add_u32 v9, 2048, v9
    v_cmp_gt_u32 vcc, 8, v7
    s_nop 1
    v_cndmask_b32 v8, v8, v9, vcc
    v_lshl_add_u32 v8, v3, 4, v8
    buffer_load_dwordx4 v[124:127], v8, s[8:11], 0 offen
    v_add_u32 v7, 32, v4
    v_subrev_u32 v8, 8, v7
    v_mul_u32_u24 v8, 24576, v8
    v_add_u32 v8, s16, v8
    v_add_u32 v8, 16384, v8
    v_lshlrev_b32 v9, 8, v7
    v_add_u32 v9, s18, v9
    v_add_u32 v9, 2048, v9
    v_cmp_gt_u32 vcc, 8, v7
    s_nop 1
    v_cndmask_b32 v8, v8, v9, vcc
    v_lshl_add_u32 v8, v3, 4, v8
    buffer_load_dwordx4 v[128:131], v8, s[8:11], 0 offen
    v_add_u32 v7, 36, v4
    v_subrev_u32 v8, 8, v7
    v_mul_u32_u24 v8, 24576, v8
    v_add_u32 v8, s16, v8
    v_add_u32 v8, 16384, v8
    v_lshlrev_b32 v9, 8, v7
    v_add_u32 v9, s18, v9
    v_add_u32 v9, 2048, v9
    v_cmp_gt_u32 vcc, 8, v7
    s_nop 1
    v_cndmask_b32 v8, v8, v9, vcc
    v_lshl_add_u32 v8, v3, 4, v8
    buffer_load_dwordx4 v[132:135], v8, s[8:11], 0 offen
    v_mul_u32_u24 v7, 288, v4
    v_lshl_add_u32 v7, v3, 4, v7
    v_add_u32 v7, s19, v7
    v_mov_b32 v140, 0
    v_mov_b32 v141, 0
    v_mov_b32 v142, 0
    v_mov_b32 v143, 0
    s_waitcnt vmcnt(0)
    ds_write_b128 v7, v[96:99] offset:0
    ds_write_b128 v7, v[100:103] offset:1152
    ds_write_b128 v7, v[104:107] offset:2304
    ds_write_b128 v7, v[108:111] offset:3456
    ds_write_b128 v7, v[112:115] offset:4608
    ds_write_b128 v7, v[116:119] offset:5760
    ds_write_b128 v7, v[120:123] offset:6912
    ds_write_b128 v7, v[124:127] offset:8064
    ds_write_b128 v7, v[128:131] offset:9216
    ds_write_b128 v7, v[132:135] offset:10368
    ds_write_b128 v7, v[140:143] offset:11520
    ds_write_b128 v7, v[140:143] offset:12672
    v_lshrrev_b32 v10, 2, v3
    v_lshl_add_u32 v10, v4, 2, v10
    v_mul_u32_u24 v10, 288, v10
    v_and_b32 v7, 3, v3
    v_lshl_add_u32 v10, v7, 3, v10
    v_add_u32 v10, s19, v10
    v_lshlrev_b32 v11, 2, v1
    v_lshlrev_b32 v12, 13, v3
    v_lshl_add_u32 v12, v4, 3, v12
    s_lshl_b32 s20, s14, 18
    s_add_u32 s20, s20, s17
    s_add_u32 s20, s20, 75497472
    s_waitcnt lgkmcnt(0)
    v_mov_b32 v96, 0
    v_mov_b32 v97, 0
    v_mov_b32 v98, 0
    v_mov_b32 v99, 0
    v_mov_b32 v100, 0
    v_mov_b32 v101, 0
    v_mov_b32 v102, 0
    v_mov_b32 v103, 0
    v_mov_b32 v104, 0
    v_mov_b32 v105, 0
    v_mov_b32 v106, 0
    v_mov_b32 v107, 0
    s_nop 1
    v_mfma_f32_16x16x32_bf16 v[96:99], v[48:51], v[16:19], v[96:99]
    v_mfma_f32_16x16x32_bf16 v[100:103], v[64:67], v[16:19], v[100:103]
    v_mfma_f32_16x16x32_bf16 v[104:107], v[80:83], v[16:19], v[104:107]
    v_mfma_f32_16x16x32_bf16 v[96:99], v[52:55], v[20:23], v[96:99]
    v_mfma_f32_16x16x32_bf16 v[100:103], v[68:71], v[20:23], v[100:103]
    v_mfma_f32_16x16x32_bf16 v[104:107], v[84:87], v[20:23], v[104:107]
    v_mfma_f32_16x16x32_bf16 v[96:99], v[56:59], v[24:27], v[96:99]
    v_mfma_f32_16x16x32_bf16 v[100:103], v[72:75], v[24:27], v[100:103]
    v_mfma_f32_16x16x32_bf16 v[104:107], v[88:91], v[24:27], v[104:107]
    v_mfma_f32_16x16x32_bf16 v[96:99], v[60:63], v[28:31], v[96:99]
    v_mfma_f32_16x16x32_bf16 v[100:103], v[76:79], v[28:31], v[100:103]
    v_mfma_f32_16x16x32_bf16 v[104:107], v[92:95], v[28:31], v[104:107]
    s_nop 7
    s_nop 1
    s_mov_b32 s21, 0x3db504f3
    s_mov_b32 s22, 0xce6e6b28
    v_add_u32 v13, 8, v3
    v_mov_b32 v14, s22
    v_cvt_pk_bf16_f32 v111, v96, v96
    v_lshlrev_b32 v96, 16, v111
    v_mul_f32 v96, s21, v96
    v_cvt_pk_bf16_f32 v111, v96, v96
    v_lshlrev_b32 v96, 16, v111
    v_lshl_add_u32 v15, v4, 2, 0
    v_cmp_gt_u32 vcc, v15, v13
    s_nop 1
    v_cndmask_b32 v96, v96, v14, vcc
    v_cvt_pk_bf16_f32 v111, v97, v97
    v_lshlrev_b32 v97, 16, v111
    v_mul_f32 v97, s21, v97
    v_cvt_pk_bf16_f32 v111, v97, v97
    v_lshlrev_b32 v97, 16, v111
    v_lshl_add_u32 v15, v4, 2, 1
    v_cmp_gt_u32 vcc, v15, v13
    s_nop 1
    v_cndmask_b32 v97, v97, v14, vcc
    v_cvt_pk_bf16_f32 v111, v98, v98
    v_lshlrev_b32 v98, 16, v111
    v_mul_f32 v98, s21, v98
    v_cvt_pk_bf16_f32 v111, v98, v98
    v_lshlrev_b32 v98, 16, v111
    v_lshl_add_u32 v15, v4, 2, 2
    v_cmp_gt_u32 vcc, v15, v13
    s_nop 1
    v_cndmask_b32 v98, v98, v14, vcc
    v_cvt_pk_bf16_f32 v111, v99, v99
    v_lshlrev_b32 v99, 16, v111
    v_mul_f32 v99, s21, v99
    v_cvt_pk_bf16_f32 v111, v99, v99
    v_lshlrev_b32 v99, 16, v111
    v_lshl_add_u32 v15, v4, 2, 3
    v_cmp_gt_u32 vcc, v15, v13
    s_nop 1
    v_cndmask_b32 v99, v99, v14, vcc
    v_cvt_pk_bf16_f32 v111, v100, v100
    v_lshlrev_b32 v100, 16, v111
    v_mul_f32 v100, s21, v100
    v_cvt_pk_bf16_f32 v111, v100, v100
    v_lshlrev_b32 v100, 16, v111
    v_lshl_add_u32 v15, v4, 2, 16
    v_cmp_gt_u32 vcc, v15, v13
    s_nop 1
    v_cndmask_b32 v100, v100, v14, vcc
    v_cvt_pk_bf16_f32 v111, v101, v101
    v_lshlrev_b32 v101, 16, v111
    v_mul_f32 v101, s21, v101
    v_cvt_pk_bf16_f32 v111, v101, v101
    v_lshlrev_b32 v101, 16, v111
    v_lshl_add_u32 v15, v4, 2, 17
    v_cmp_gt_u32 vcc, v15, v13
    s_nop 1
    v_cndmask_b32 v101, v101, v14, vcc
    v_cvt_pk_bf16_f32 v111, v102, v102
    v_lshlrev_b32 v102, 16, v111
    v_mul_f32 v102, s21, v102
    v_cvt_pk_bf16_f32 v111, v102, v102
    v_lshlrev_b32 v102, 16, v111
    v_lshl_add_u32 v15, v4, 2, 18
    v_cmp_gt_u32 vcc, v15, v13
    s_nop 1
    v_cndmask_b32 v102, v102, v14, vcc
    v_cvt_pk_bf16_f32 v111, v103, v103
    v_lshlrev_b32 v103, 16, v111
    v_mul_f32 v103, s21, v103
    v_cvt_pk_bf16_f32 v111, v103, v103
    v_lshlrev_b32 v103, 16, v111
    v_lshl_add_u32 v15, v4, 2, 19
    v_cmp_gt_u32 vcc, v15, v13
    s_nop 1
    v_cndmask_b32 v103, v103, v14, vcc
    v_cvt_pk_bf16_f32 v111, v104, v104
    v_lshlrev_b32 v104, 16, v111
    v_mul_f32 v104, s21, v104
    v_cvt_pk_bf16_f32 v111, v104, v104
    v_lshlrev_b32 v104, 16, v111
    v_lshl_add_u32 v15, v4, 2, 32
    v_cmp_gt_u32 vcc, v15, v13
    s_nop 1
    v_cndmask_b32 v104, v104, v14, vcc
    v_cvt_pk_bf16_f32 v111, v105, v105
    v_lshlrev_b32 v105, 16, v111
    v_mul_f32 v105, s21, v105
    v_cvt_pk_bf16_f32 v111, v105, v105
    v_lshlrev_b32 v105, 16, v111
    v_lshl_add_u32 v15, v4, 2, 33
    v_cmp_gt_u32 vcc, v15, v13
    s_nop 1
    v_cndmask_b32 v105, v105, v14, vcc
    v_cvt_pk_bf16_f32 v111, v106, v106
    v_lshlrev_b32 v106, 16, v111
    v_mul_f32 v106, s21, v106
    v_cvt_pk_bf16_f32 v111, v106, v106
    v_lshlrev_b32 v106, 16, v111
    v_lshl_add_u32 v15, v4, 2, 34
    v_cmp_gt_u32 vcc, v15, v13
    s_nop 1
    v_cndmask_b32 v106, v106, v14, vcc
    v_cvt_pk_bf16_f32 v111, v107, v107
    v_lshlrev_b32 v107, 16, v111
    v_mul_f32 v107, s21, v107
    v_cvt_pk_bf16_f32 v111, v107, v107
    v_lshlrev_b32 v107, 16, v111
    v_lshl_add_u32 v15, v4, 2, 35
    v_cmp_gt_u32 vcc, v15, v13
    s_nop 1
    v_cndmask_b32 v107, v107, v14, vcc
    v_max_f32 v110, v96, v97
    v_max_f32 v110, v110, v98
    v_max_f32 v110, v110, v99
    v_max_f32 v110, v110, v100
    v_max_f32 v110, v110, v101
    v_max_f32 v110, v110, v102
    v_max_f32 v110, v110, v103
    v_max_f32 v110, v110, v104
    v_max_f32 v110, v110, v105
    v_max_f32 v110, v110, v106
    v_max_f32 v110, v110, v107
    v_xor_b32 v15, 64, v11
    ds_bpermute_b32 v111, v15, v110
    s_waitcnt lgkmcnt(0)
    v_max_f32 v110, v110, v111
    v_xor_b32 v15, 128, v11
    ds_bpermute_b32 v111, v15, v110
    s_waitcnt lgkmcnt(0)
    v_max_f32 v110, v110, v111
    s_mov_b32 s21, 0x3fb8aa3b
    v_sub_f32 v96, v96, v110
    v_mul_f32 v96, s21, v96
    v_exp_f32 v96, v96
    v_sub_f32 v97, v97, v110
    v_mul_f32 v97, s21, v97
    v_exp_f32 v97, v97
    v_sub_f32 v98, v98, v110
    v_mul_f32 v98, s21, v98
    v_exp_f32 v98, v98
    v_sub_f32 v99, v99, v110
    v_mul_f32 v99, s21, v99
    v_exp_f32 v99, v99
    v_sub_f32 v100, v100, v110
    v_mul_f32 v100, s21, v100
    v_exp_f32 v100, v100
    v_sub_f32 v101, v101, v110
    v_mul_f32 v101, s21, v101
    v_exp_f32 v101, v101
    v_sub_f32 v102, v102, v110
    v_mul_f32 v102, s21, v102
    v_exp_f32 v102, v102
    v_sub_f32 v103, v103, v110
    v_mul_f32 v103, s21, v103
    v_exp_f32 v103, v103
    v_sub_f32 v104, v104, v110
    v_mul_f32 v104, s21, v104
    v_exp_f32 v104, v104
    v_sub_f32 v105, v105, v110
    v_mul_f32 v105, s21, v105
    v_exp_f32 v105, v105
    v_sub_f32 v106, v106, v110
    v_mul_f32 v106, s21, v106
    v_exp_f32 v106, v106
    v_sub_f32 v107, v107, v110
    v_mul_f32 v107, s21, v107
    v_exp_f32 v107, v107
    s_nop 0
    v_add_f32 v110, v96, v97
    v_add_f32 v110, v110, v98
    v_add_f32 v110, v110, v99
    v_add_f32 v110, v110, v100
    v_add_f32 v110, v110, v101
    v_add_f32 v110, v110, v102
    v_add_f32 v110, v110, v103
    v_add_f32 v110, v110, v104
    v_add_f32 v110, v110, v105
    v_add_f32 v110, v110, v106
    v_add_f32 v110, v110, v107
    v_xor_b32 v15, 64, v11
    ds_bpermute_b32 v111, v15, v110
    s_waitcnt lgkmcnt(0)
    v_add_f32 v110, v110, v111
    v_xor_b32 v15, 128, v11
    ds_bpermute_b32 v111, v15, v110
    s_waitcnt lgkmcnt(0)
    v_add_f32 v110, v110, v111
    v_rcp_f32 v109, v110
    s_nop 0
    v_mul_f32 v111, v96, v109
    v_fma_f32 v108, -v111, v110, v96
    v_fma_f32 v96, v108, v109, v111
    v_mul_f32 v111, v97, v109
    v_fma_f32 v108, -v111, v110, v97
    v_fma_f32 v97, v108, v109, v111
    v_mul_f32 v111, v98, v109
    v_fma_f32 v108, -v111, v110, v98
    v_fma_f32 v98, v108, v109, v111
    v_mul_f32 v111, v99, v109
    v_fma_f32 v108, -v111, v110, v99
    v_fma_f32 v99, v108, v109, v111
    v_mul_f32 v111, v100, v109
    v_fma_f32 v108, -v111, v110, v100
    v_fma_f32 v100, v108, v109, v111
    v_mul_f32 v111, v101, v109
    v_fma_f32 v108, -v111, v110, v101
    v_fma_f32 v101, v108, v109, v111
    v_mul_f32 v111, v102, v109
    v_fma_f32 v108, -v111, v110, v102
    v_fma_f32 v102, v108, v109, v111
    v_mul_f32 v111, v103, v109
    v_fma_f32 v108, -v111, v110, v103
    v_fma_f32 v103, v108, v109, v111
    v_mul_f32 v111, v104, v109
    v_fma_f32 v108, -v111, v110, v104
    v_fma_f32 v104, v108, v109, v111
    v_mul_f32 v111, v105, v109
    v_fma_f32 v108, -v111, v110, v105
    v_fma_f32 v105, v108, v109, v111
    v_mul_f32 v111, v106, v109
    v_fma_f32 v108, -v111, v110, v106
    v_fma_f32 v106, v108, v109, v111
    v_mul_f32 v111, v107, v109
    v_fma_f32 v108, -v111, v110, v107
    v_fma_f32 v107, v108, v109, v111
    v_cvt_pk_bf16_f32 v112, v96, v97
    v_cvt_pk_bf16_f32 v113, v98, v99
    v_cvt_pk_bf16_f32 v114, v100, v101
    v_cvt_pk_bf16_f32 v115, v102, v103
    v_cvt_pk_bf16_f32 v116, v104, v105
    v_cvt_pk_bf16_f32 v117, v106, v107
    v_mov_b32 v118, 0
    v_mov_b32 v119, 0
    v_mov_b32 v126, 0
    v_mov_b32 v127, 0
    ds_read_b64_tr_b16 v[120:121], v10 offset:0
    ds_read_b64_tr_b16 v[122:123], v10 offset:4608
    ds_read_b64_tr_b16 v[124:125], v10 offset:9216
    v_mov_b32 v128, 0
    v_mov_b32 v129, 0
    v_mov_b32 v130, 0
    v_mov_b32 v131, 0
    s_waitcnt lgkmcnt(0)
    v_mfma_f32_16x16x32_bf16 v[128:131], v[120:123], v[112:115], v[128:131]
    v_mfma_f32_16x16x32_bf16 v[128:131], v[124:127], v[116:119], v[128:131]
    s_nop 7
    s_nop 1
    v_cvt_pk_bf16_f32 v132, v128, v129
    v_cvt_pk_bf16_f32 v133, v130, v131
    buffer_store_dwordx2 v[132:133], v12, s[8:11], s20 offen offset:0
    ds_read_b64_tr_b16 v[120:121], v10 offset:32
    ds_read_b64_tr_b16 v[122:123], v10 offset:4640
    ds_read_b64_tr_b16 v[124:125], v10 offset:9248
    v_mov_b32 v128, 0
    v_mov_b32 v129, 0
    v_mov_b32 v130, 0
    v_mov_b32 v131, 0
    s_waitcnt lgkmcnt(0)
    v_mfma_f32_16x16x32_bf16 v[128:131], v[120:123], v[112:115], v[128:131]
    v_mfma_f32_16x16x32_bf16 v[128:131], v[124:127], v[116:119], v[128:131]
    s_nop 7
    s_nop 1
    v_cvt_pk_bf16_f32 v132, v128, v129
    v_cvt_pk_bf16_f32 v133, v130, v131
    buffer_store_dwordx2 v[132:133], v12, s[8:11], s20 offen offset:32
    ds_read_b64_tr_b16 v[120:121], v10 offset:64
    ds_read_b64_tr_b16 v[122:123], v10 offset:4672
    ds_read_b64_tr_b16 v[124:125], v10 offset:9280
    v_mov_b32 v128, 0
    v_mov_b32 v129, 0
    v_mov_b32 v130, 0
    v_mov_b32 v131, 0
    s_waitcnt lgkmcnt(0)
    v_mfma_f32_16x16x32_bf16 v[128:131], v[120:123], v[112:115], v[128:131]
    v_mfma_f32_16x16x32_bf16 v[128:131], v[124:127], v[116:119], v[128:131]
    s_nop 7
    s_nop 1
    v_cvt_pk_bf16_f32 v132, v128, v129
    v_cvt_pk_bf16_f32 v133, v130, v131
    buffer_store_dwordx2 v[132:133], v12, s[8:11], s20 offen offset:64
    ds_read_b64_tr_b16 v[120:121], v10 offset:96
    ds_read_b64_tr_b16 v[122:123], v10 offset:4704
    ds_read_b64_tr_b16 v[124:125], v10 offset:9312
    v_mov_b32 v128, 0
    v_mov_b32 v129, 0
    v_mov_b32 v130, 0
    v_mov_b32 v131, 0
    s_waitcnt lgkmcnt(0)
    v_mfma_f32_16x16x32_bf16 v[128:131], v[120:123], v[112:115], v[128:131]
    v_mfma_f32_16x16x32_bf16 v[128:131], v[124:127], v[116:119], v[128:131]
    s_nop 7
    s_nop 1
    v_cvt_pk_bf16_f32 v132, v128, v129
    v_cvt_pk_bf16_f32 v133, v130, v131
    buffer_store_dwordx2 v[132:133], v12, s[8:11], s20 offen offset:96
    ds_read_b64_tr_b16 v[120:121], v10 offset:128
    ds_read_b64_tr_b16 v[122:123], v10 offset:4736
    ds_read_b64_tr_b16 v[124:125], v10 offset:9344
    v_mov_b32 v128, 0
    v_mov_b32 v129, 0
    v_mov_b32 v130, 0
    v_mov_b32 v131, 0
    s_waitcnt lgkmcnt(0)
    v_mfma_f32_16x16x32_bf16 v[128:131], v[120:123], v[112:115], v[128:131]
    v_mfma_f32_16x16x32_bf16 v[128:131], v[124:127], v[116:119], v[128:131]
    s_nop 7
    s_nop 1
    v_cvt_pk_bf16_f32 v132, v128, v129
    v_cvt_pk_bf16_f32 v133, v130, v131
    buffer_store_dwordx2 v[132:133], v12, s[8:11], s20 offen offset:128
    ds_read_b64_tr_b16 v[120:121], v10 offset:160
    ds_read_b64_tr_b16 v[122:123], v10 offset:4768
    ds_read_b64_tr_b16 v[124:125], v10 offset:9376
    v_mov_b32 v128, 0
    v_mov_b32 v129, 0
    v_mov_b32 v130, 0
    v_mov_b32 v131, 0
    s_waitcnt lgkmcnt(0)
    v_mfma_f32_16x16x32_bf16 v[128:131], v[120:123], v[112:115], v[128:131]
    v_mfma_f32_16x16x32_bf16 v[128:131], v[124:127], v[116:119], v[128:131]
    s_nop 7
    s_nop 1
    v_cvt_pk_bf16_f32 v132, v128, v129
    v_cvt_pk_bf16_f32 v133, v130, v131
    buffer_store_dwordx2 v[132:133], v12, s[8:11], s20 offen offset:160
    ds_read_b64_tr_b16 v[120:121], v10 offset:192
    ds_read_b64_tr_b16 v[122:123], v10 offset:4800
    ds_read_b64_tr_b16 v[124:125], v10 offset:9408
    v_mov_b32 v128, 0
    v_mov_b32 v129, 0
    v_mov_b32 v130, 0
    v_mov_b32 v131, 0
    s_waitcnt lgkmcnt(0)
    v_mfma_f32_16x16x32_bf16 v[128:131], v[120:123], v[112:115], v[128:131]
    v_mfma_f32_16x16x32_bf16 v[128:131], v[124:127], v[116:119], v[128:131]
    s_nop 7
    s_nop 1
    v_cvt_pk_bf16_f32 v132, v128, v129
    v_cvt_pk_bf16_f32 v133, v130, v131
    buffer_store_dwordx2 v[132:133], v12, s[8:11], s20 offen offset:192
    ds_read_b64_tr_b16 v[120:121], v10 offset:224
    ds_read_b64_tr_b16 v[122:123], v10 offset:4832
    ds_read_b64_tr_b16 v[124:125], v10 offset:9440
    v_mov_b32 v128, 0
    v_mov_b32 v129, 0
    v_mov_b32 v130, 0
    v_mov_b32 v131, 0
    s_waitcnt lgkmcnt(0)
    v_mfma_f32_16x16x32_bf16 v[128:131], v[120:123], v[112:115], v[128:131]
    v_mfma_f32_16x16x32_bf16 v[128:131], v[124:127], v[116:119], v[128:131]
    s_nop 7
    s_nop 1
    v_cvt_pk_bf16_f32 v132, v128, v129
    v_cvt_pk_bf16_f32 v133, v130, v131
    buffer_store_dwordx2 v[132:133], v12, s[8:11], s20 offen offset:224
    s_add_u32 s20, s20, 131072
    v_mov_b32 v96, 0
    v_mov_b32 v97, 0
    v_mov_b32 v98, 0
    v_mov_b32 v99, 0
    v_mov_b32 v100, 0
    v_mov_b32 v101, 0
    v_mov_b32 v102, 0
    v_mov_b32 v103, 0
    v_mov_b32 v104, 0
    v_mov_b32 v105, 0
    v_mov_b32 v106, 0
    v_mov_b32 v107, 0
    s_nop 1
    v_mfma_f32_16x16x32_bf16 v[96:99], v[48:51], v[32:35], v[96:99]
    v_mfma_f32_16x16x32_bf16 v[100:103], v[64:67], v[32:35], v[100:103]
    v_mfma_f32_16x16x32_bf16 v[104:107], v[80:83], v[32:35], v[104:107]
    v_mfma_f32_16x16x32_bf16 v[96:99], v[52:55], v[36:39], v[96:99]
    v_mfma_f32_16x16x32_bf16 v[100:103], v[68:71], v[36:39], v[100:103]
    v_mfma_f32_16x16x32_bf16 v[104:107], v[84:87], v[36:39], v[104:107]
    v_mfma_f32_16x16x32_bf16 v[96:99], v[56:59], v[40:43], v[96:99]
    v_mfma_f32_16x16x32_bf16 v[100:103], v[72:75], v[40:43], v[100:103]
    v_mfma_f32_16x16x32_bf16 v[104:107], v[88:91], v[40:43], v[104:107]
    v_mfma_f32_16x16x32_bf16 v[96:99], v[60:63], v[44:47], v[96:99]
    v_mfma_f32_16x16x32_bf16 v[100:103], v[76:79], v[44:47], v[100:103]
    v_mfma_f32_16x16x32_bf16 v[104:107], v[92:95], v[44:47], v[104:107]
    s_nop 7
    s_nop 1
    s_mov_b32 s21, 0x3db504f3
    s_mov_b32 s22, 0xce6e6b28
    v_add_u32 v13, 24, v3
    v_mov_b32 v14, s22
    v_cvt_pk_bf16_f32 v111, v96, v96
    v_lshlrev_b32 v96, 16, v111
    v_mul_f32 v96, s21, v96
    v_cvt_pk_bf16_f32 v111, v96, v96
    v_lshlrev_b32 v96, 16, v111
    v_lshl_add_u32 v15, v4, 2, 0
    v_cmp_gt_u32 vcc, v15, v13
    s_nop 1
    v_cndmask_b32 v96, v96, v14, vcc
    v_cvt_pk_bf16_f32 v111, v97, v97
    v_lshlrev_b32 v97, 16, v111
    v_mul_f32 v97, s21, v97
    v_cvt_pk_bf16_f32 v111, v97, v97
    v_lshlrev_b32 v97, 16, v111
    v_lshl_add_u32 v15, v4, 2, 1
    v_cmp_gt_u32 vcc, v15, v13
    s_nop 1
    v_cndmask_b32 v97, v97, v14, vcc
    v_cvt_pk_bf16_f32 v111, v98, v98
    v_lshlrev_b32 v98, 16, v111
    v_mul_f32 v98, s21, v98
    v_cvt_pk_bf16_f32 v111, v98, v98
    v_lshlrev_b32 v98, 16, v111
    v_lshl_add_u32 v15, v4, 2, 2
    v_cmp_gt_u32 vcc, v15, v13
    s_nop 1
    v_cndmask_b32 v98, v98, v14, vcc
    v_cvt_pk_bf16_f32 v111, v99, v99
    v_lshlrev_b32 v99, 16, v111
    v_mul_f32 v99, s21, v99
    v_cvt_pk_bf16_f32 v111, v99, v99
    v_lshlrev_b32 v99, 16, v111
    v_lshl_add_u32 v15, v4, 2, 3
    v_cmp_gt_u32 vcc, v15, v13
    s_nop 1
    v_cndmask_b32 v99, v99, v14, vcc
    v_cvt_pk_bf16_f32 v111, v100, v100
    v_lshlrev_b32 v100, 16, v111
    v_mul_f32 v100, s21, v100
    v_cvt_pk_bf16_f32 v111, v100, v100
    v_lshlrev_b32 v100, 16, v111
    v_lshl_add_u32 v15, v4, 2, 16
    v_cmp_gt_u32 vcc, v15, v13
    s_nop 1
    v_cndmask_b32 v100, v100, v14, vcc
    v_cvt_pk_bf16_f32 v111, v101, v101
    v_lshlrev_b32 v101, 16, v111
    v_mul_f32 v101, s21, v101
    v_cvt_pk_bf16_f32 v111, v101, v101
    v_lshlrev_b32 v101, 16, v111
    v_lshl_add_u32 v15, v4, 2, 17
    v_cmp_gt_u32 vcc, v15, v13
    s_nop 1
    v_cndmask_b32 v101, v101, v14, vcc
    v_cvt_pk_bf16_f32 v111, v102, v102
    v_lshlrev_b32 v102, 16, v111
    v_mul_f32 v102, s21, v102
    v_cvt_pk_bf16_f32 v111, v102, v102
    v_lshlrev_b32 v102, 16, v111
    v_lshl_add_u32 v15, v4, 2, 18
    v_cmp_gt_u32 vcc, v15, v13
    s_nop 1
    v_cndmask_b32 v102, v102, v14, vcc
    v_cvt_pk_bf16_f32 v111, v103, v103
    v_lshlrev_b32 v103, 16, v111
    v_mul_f32 v103, s21, v103
    v_cvt_pk_bf16_f32 v111, v103, v103
    v_lshlrev_b32 v103, 16, v111
    v_lshl_add_u32 v15, v4, 2, 19
    v_cmp_gt_u32 vcc, v15, v13
    s_nop 1
    v_cndmask_b32 v103, v103, v14, vcc
    v_cvt_pk_bf16_f32 v111, v104, v104
    v_lshlrev_b32 v104, 16, v111
    v_mul_f32 v104, s21, v104
    v_cvt_pk_bf16_f32 v111, v104, v104
    v_lshlrev_b32 v104, 16, v111
    v_lshl_add_u32 v15, v4, 2, 32
    v_cmp_gt_u32 vcc, v15, v13
    s_nop 1
    v_cndmask_b32 v104, v104, v14, vcc
    v_cvt_pk_bf16_f32 v111, v105, v105
    v_lshlrev_b32 v105, 16, v111
    v_mul_f32 v105, s21, v105
    v_cvt_pk_bf16_f32 v111, v105, v105
    v_lshlrev_b32 v105, 16, v111
    v_lshl_add_u32 v15, v4, 2, 33
    v_cmp_gt_u32 vcc, v15, v13
    s_nop 1
    v_cndmask_b32 v105, v105, v14, vcc
    v_cvt_pk_bf16_f32 v111, v106, v106
    v_lshlrev_b32 v106, 16, v111
    v_mul_f32 v106, s21, v106
    v_cvt_pk_bf16_f32 v111, v106, v106
    v_lshlrev_b32 v106, 16, v111
    v_lshl_add_u32 v15, v4, 2, 34
    v_cmp_gt_u32 vcc, v15, v13
    s_nop 1
    v_cndmask_b32 v106, v106, v14, vcc
    v_cvt_pk_bf16_f32 v111, v107, v107
    v_lshlrev_b32 v107, 16, v111
    v_mul_f32 v107, s21, v107
    v_cvt_pk_bf16_f32 v111, v107, v107
    v_lshlrev_b32 v107, 16, v111
    v_lshl_add_u32 v15, v4, 2, 35
    v_cmp_gt_u32 vcc, v15, v13
    s_nop 1
    v_cndmask_b32 v107, v107, v14, vcc
    v_max_f32 v110, v96, v97
    v_max_f32 v110, v110, v98
    v_max_f32 v110, v110, v99
    v_max_f32 v110, v110, v100
    v_max_f32 v110, v110, v101
    v_max_f32 v110, v110, v102
    v_max_f32 v110, v110, v103
    v_max_f32 v110, v110, v104
    v_max_f32 v110, v110, v105
    v_max_f32 v110, v110, v106
    v_max_f32 v110, v110, v107
    v_xor_b32 v15, 64, v11
    ds_bpermute_b32 v111, v15, v110
    s_waitcnt lgkmcnt(0)
    v_max_f32 v110, v110, v111
    v_xor_b32 v15, 128, v11
    ds_bpermute_b32 v111, v15, v110
    s_waitcnt lgkmcnt(0)
    v_max_f32 v110, v110, v111
    s_mov_b32 s21, 0x3fb8aa3b
    v_sub_f32 v96, v96, v110
    v_mul_f32 v96, s21, v96
    v_exp_f32 v96, v96
    v_sub_f32 v97, v97, v110
    v_mul_f32 v97, s21, v97
    v_exp_f32 v97, v97
    v_sub_f32 v98, v98, v110
    v_mul_f32 v98, s21, v98
    v_exp_f32 v98, v98
    v_sub_f32 v99, v99, v110
    v_mul_f32 v99, s21, v99
    v_exp_f32 v99, v99
    v_sub_f32 v100, v100, v110
    v_mul_f32 v100, s21, v100
    v_exp_f32 v100, v100
    v_sub_f32 v101, v101, v110
    v_mul_f32 v101, s21, v101
    v_exp_f32 v101, v101
    v_sub_f32 v102, v102, v110
    v_mul_f32 v102, s21, v102
    v_exp_f32 v102, v102
    v_sub_f32 v103, v103, v110
    v_mul_f32 v103, s21, v103
    v_exp_f32 v103, v103
    v_sub_f32 v104, v104, v110
    v_mul_f32 v104, s21, v104
    v_exp_f32 v104, v104
    v_sub_f32 v105, v105, v110
    v_mul_f32 v105, s21, v105
    v_exp_f32 v105, v105
    v_sub_f32 v106, v106, v110
    v_mul_f32 v106, s21, v106
    v_exp_f32 v106, v106
    v_sub_f32 v107, v107, v110
    v_mul_f32 v107, s21, v107
    v_exp_f32 v107, v107
    s_nop 0
    v_add_f32 v110, v96, v97
    v_add_f32 v110, v110, v98
    v_add_f32 v110, v110, v99
    v_add_f32 v110, v110, v100
    v_add_f32 v110, v110, v101
    v_add_f32 v110, v110, v102
    v_add_f32 v110, v110, v103
    v_add_f32 v110, v110, v104
    v_add_f32 v110, v110, v105
    v_add_f32 v110, v110, v106
    v_add_f32 v110, v110, v107
    v_xor_b32 v15, 64, v11
    ds_bpermute_b32 v111, v15, v110
    s_waitcnt lgkmcnt(0)
    v_add_f32 v110, v110, v111
    v_xor_b32 v15, 128, v11
    ds_bpermute_b32 v111, v15, v110
    s_waitcnt lgkmcnt(0)
    v_add_f32 v110, v110, v111
    v_rcp_f32 v109, v110
    s_nop 0
    v_mul_f32 v111, v96, v109
    v_fma_f32 v108, -v111, v110, v96
    v_fma_f32 v96, v108, v109, v111
    v_mul_f32 v111, v97, v109
    v_fma_f32 v108, -v111, v110, v97
    v_fma_f32 v97, v108, v109, v111
    v_mul_f32 v111, v98, v109
    v_fma_f32 v108, -v111, v110, v98
    v_fma_f32 v98, v108, v109, v111
    v_mul_f32 v111, v99, v109
    v_fma_f32 v108, -v111, v110, v99
    v_fma_f32 v99, v108, v109, v111
    v_mul_f32 v111, v100, v109
    v_fma_f32 v108, -v111, v110, v100
    v_fma_f32 v100, v108, v109, v111
    v_mul_f32 v111, v101, v109
    v_fma_f32 v108, -v111, v110, v101
    v_fma_f32 v101, v108, v109, v111
    v_mul_f32 v111, v102, v109
    v_fma_f32 v108, -v111, v110, v102
    v_fma_f32 v102, v108, v109, v111
    v_mul_f32 v111, v103, v109
    v_fma_f32 v108, -v111, v110, v103
    v_fma_f32 v103, v108, v109, v111
    v_mul_f32 v111, v104, v109
    v_fma_f32 v108, -v111, v110, v104
    v_fma_f32 v104, v108, v109, v111
    v_mul_f32 v111, v105, v109
    v_fma_f32 v108, -v111, v110, v105
    v_fma_f32 v105, v108, v109, v111
    v_mul_f32 v111, v106, v109
    v_fma_f32 v108, -v111, v110, v106
    v_fma_f32 v106, v108, v109, v111
    v_mul_f32 v111, v107, v109
    v_fma_f32 v108, -v111, v110, v107
    v_fma_f32 v107, v108, v109, v111
    v_cvt_pk_bf16_f32 v112, v96, v97
    v_cvt_pk_bf16_f32 v113, v98, v99
    v_cvt_pk_bf16_f32 v114, v100, v101
    v_cvt_pk_bf16_f32 v115, v102, v103
    v_cvt_pk_bf16_f32 v116, v104, v105
    v_cvt_pk_bf16_f32 v117, v106, v107
    v_mov_b32 v118, 0
    v_mov_b32 v119, 0
    v_mov_b32 v126, 0
    v_mov_b32 v127, 0
    ds_read_b64_tr_b16 v[120:121], v10 offset:0
    ds_read_b64_tr_b16 v[122:123], v10 offset:4608
    ds_read_b64_tr_b16 v[124:125], v10 offset:9216
    v_mov_b32 v128, 0
    v_mov_b32 v129, 0
    v_mov_b32 v130, 0
    v_mov_b32 v131, 0
    s_waitcnt lgkmcnt(0)
    v_mfma_f32_16x16x32_bf16 v[128:131], v[120:123], v[112:115], v[128:131]
    v_mfma_f32_16x16x32_bf16 v[128:131], v[124:127], v[116:119], v[128:131]
    s_nop 7
    s_nop 1
    v_cvt_pk_bf16_f32 v132, v128, v129
    v_cvt_pk_bf16_f32 v133, v130, v131
    buffer_store_dwordx2 v[132:133], v12, s[8:11], s20 offen offset:0
    ds_read_b64_tr_b16 v[120:121], v10 offset:32
    ds_read_b64_tr_b16 v[122:123], v10 offset:4640
    ds_read_b64_tr_b16 v[124:125], v10 offset:9248
    v_mov_b32 v128, 0
    v_mov_b32 v129, 0
    v_mov_b32 v130, 0
    v_mov_b32 v131, 0
    s_waitcnt lgkmcnt(0)
    v_mfma_f32_16x16x32_bf16 v[128:131], v[120:123], v[112:115], v[128:131]
    v_mfma_f32_16x16x32_bf16 v[128:131], v[124:127], v[116:119], v[128:131]
    s_nop 7
    s_nop 1
    v_cvt_pk_bf16_f32 v132, v128, v129
    v_cvt_pk_bf16_f32 v133, v130, v131
    buffer_store_dwordx2 v[132:133], v12, s[8:11], s20 offen offset:32
    ds_read_b64_tr_b16 v[120:121], v10 offset:64
    ds_read_b64_tr_b16 v[122:123], v10 offset:4672
    ds_read_b64_tr_b16 v[124:125], v10 offset:9280
    v_mov_b32 v128, 0
    v_mov_b32 v129, 0
    v_mov_b32 v130, 0
    v_mov_b32 v131, 0
    s_waitcnt lgkmcnt(0)
    v_mfma_f32_16x16x32_bf16 v[128:131], v[120:123], v[112:115], v[128:131]
    v_mfma_f32_16x16x32_bf16 v[128:131], v[124:127], v[116:119], v[128:131]
    s_nop 7
    s_nop 1
    v_cvt_pk_bf16_f32 v132, v128, v129
    v_cvt_pk_bf16_f32 v133, v130, v131
    buffer_store_dwordx2 v[132:133], v12, s[8:11], s20 offen offset:64
    ds_read_b64_tr_b16 v[120:121], v10 offset:96
    ds_read_b64_tr_b16 v[122:123], v10 offset:4704
    ds_read_b64_tr_b16 v[124:125], v10 offset:9312
    v_mov_b32 v128, 0
    v_mov_b32 v129, 0
    v_mov_b32 v130, 0
    v_mov_b32 v131, 0
    s_waitcnt lgkmcnt(0)
    v_mfma_f32_16x16x32_bf16 v[128:131], v[120:123], v[112:115], v[128:131]
    v_mfma_f32_16x16x32_bf16 v[128:131], v[124:127], v[116:119], v[128:131]
    s_nop 7
    s_nop 1
    v_cvt_pk_bf16_f32 v132, v128, v129
    v_cvt_pk_bf16_f32 v133, v130, v131
    buffer_store_dwordx2 v[132:133], v12, s[8:11], s20 offen offset:96
    ds_read_b64_tr_b16 v[120:121], v10 offset:128
    ds_read_b64_tr_b16 v[122:123], v10 offset:4736
    ds_read_b64_tr_b16 v[124:125], v10 offset:9344
    v_mov_b32 v128, 0
    v_mov_b32 v129, 0
    v_mov_b32 v130, 0
    v_mov_b32 v131, 0
    s_waitcnt lgkmcnt(0)
    v_mfma_f32_16x16x32_bf16 v[128:131], v[120:123], v[112:115], v[128:131]
    v_mfma_f32_16x16x32_bf16 v[128:131], v[124:127], v[116:119], v[128:131]
    s_nop 7
    s_nop 1
    v_cvt_pk_bf16_f32 v132, v128, v129
    v_cvt_pk_bf16_f32 v133, v130, v131
    buffer_store_dwordx2 v[132:133], v12, s[8:11], s20 offen offset:128
    ds_read_b64_tr_b16 v[120:121], v10 offset:160
    ds_read_b64_tr_b16 v[122:123], v10 offset:4768
    ds_read_b64_tr_b16 v[124:125], v10 offset:9376
    v_mov_b32 v128, 0
    v_mov_b32 v129, 0
    v_mov_b32 v130, 0
    v_mov_b32 v131, 0
    s_waitcnt lgkmcnt(0)
    v_mfma_f32_16x16x32_bf16 v[128:131], v[120:123], v[112:115], v[128:131]
    v_mfma_f32_16x16x32_bf16 v[128:131], v[124:127], v[116:119], v[128:131]
    s_nop 7
    s_nop 1
    v_cvt_pk_bf16_f32 v132, v128, v129
    v_cvt_pk_bf16_f32 v133, v130, v131
    buffer_store_dwordx2 v[132:133], v12, s[8:11], s20 offen offset:160
    ds_read_b64_tr_b16 v[120:121], v10 offset:192
    ds_read_b64_tr_b16 v[122:123], v10 offset:4800
    ds_read_b64_tr_b16 v[124:125], v10 offset:9408
    v_mov_b32 v128, 0
    v_mov_b32 v129, 0
    v_mov_b32 v130, 0
    v_mov_b32 v131, 0
    s_waitcnt lgkmcnt(0)
    v_mfma_f32_16x16x32_bf16 v[128:131], v[120:123], v[112:115], v[128:131]
    v_mfma_f32_16x16x32_bf16 v[128:131], v[124:127], v[116:119], v[128:131]
    s_nop 7
    s_nop 1
    v_cvt_pk_bf16_f32 v132, v128, v129
    v_cvt_pk_bf16_f32 v133, v130, v131
    buffer_store_dwordx2 v[132:133], v12, s[8:11], s20 offen offset:192
    ds_read_b64_tr_b16 v[120:121], v10 offset:224
    ds_read_b64_tr_b16 v[122:123], v10 offset:4832
    ds_read_b64_tr_b16 v[124:125], v10 offset:9440
    v_mov_b32 v128, 0
    v_mov_b32 v129, 0
    v_mov_b32 v130, 0
    v_mov_b32 v131, 0
    s_waitcnt lgkmcnt(0)
    v_mfma_f32_16x16x32_bf16 v[128:131], v[120:123], v[112:115], v[128:131]
    v_mfma_f32_16x16x32_bf16 v[128:131], v[124:127], v[116:119], v[128:131]
    s_nop 7
    s_nop 1
    v_cvt_pk_bf16_f32 v132, v128, v129
    v_cvt_pk_bf16_f32 v133, v130, v131
    buffer_store_dwordx2 v[132:133], v12, s[8:11], s20 offen offset:224
    s_add_u32 s20, s20, 131072
at_done:
    s_endpgm
.globl gemm2_kernel
.p2align 8
.type gemm2_kernel,@function
gemm2_kernel:
    s_cmp_ge_u32 s2, 256
    s_cbranch_scc1 g2_done
    s_load_dwordx2 s[8:9], s[0:1], 112
    s_mov_b32 s10, 268435456
    s_mov_b32 s11, 0x00020000
    s_load_dwordx2 s[12:13], s[0:1], 40
    s_mov_b32 s14, 8388608
    s_mov_b32 s15, 0x00020000
    s_load_dwordx2 s[16:17], s[0:1], 80
    s_mov_b32 s18, 7340032
    s_mov_b32 s19, 0x00020000
    s_load_dwordx2 s[20:21], s[0:1], 0
    s_mov_b32 s22, 4194304
    s_mov_b32 s23, 0x00020000
    s_load_dwordx2 s[24:25], s[0:1], 88
    s_mov_b32 s26, 2048
    s_mov_b32 s27, 0x00020000
    s_load_dwordx2 s[28:29], s[0:1], 96
    s_mov_b32 s30, 4194304
    s_mov_b32 s31, 0x00020000
    s_waitcnt lgkmcnt(0)
    s_and_b32 s32, s2, 15
    s_lshl_b32 s32, s32, 7
    s_lshr_b32 s34, s2, 4
    s_lshl_b32 s34, s34, 7
    s_mov_b32 s36, 2048
    v_lshrrev_b32 v1, 3, v0
    v_and_b32 v2, 7, v0
    v_mul_u32_u24 v12, 160, v1
    v_lshl_add_u32 v12, v2, 4, v12
    v_lshrrev_b32 v1, 3, v0
    v_and_b32 v2, 7, v0
    v_mul_u32_u24 v13, 160, v1
    v_lshl_add_u32 v13, v2, 4, v13
    v_add_u32 v13, 20480, v13
    v_lshrrev_b32 v1, 6, v0
    v_and_b32 v2, 1, v1
    v_lshrrev_b32 v3, 1, v1
    v_and_b32 v16, 63, v0
    v_and_b32 v17, 15, v16
    v_lshrrev_b32 v18, 4, v16
    v_lshl_add_u32 v19, v2, 6, v17
    v_mul_u32_u24 v14, 160, v19
    v_lshl_add_u32 v14, v18, 4, v14
    v_lshrrev_b32 v19, 2, v17
    v_lshl_add_u32 v19, v18, 3, v19
    v_mul_u32_u24 v15, 160, v19
    v_and_b32 v19, 3, v17
    v_lshlrev_b32 v19, 2, v19
    v_lshl_add_u32 v19, v3, 5, v19
    v_lshl_add_u32 v15, v19, 1, v15
    v_add_u32 v15, 20480, v15
    v_add_u32 v224, 30720, v12
    v_add_u32 v225, 30720, v13
    v_add_u32 v226, 30720, v14
    v_add_u32 v227, 30720, v15
    v_mov_b32 v64, 0
    v_mov_b32 v65, 0
    v_mov_b32 v66, 0
    v_mov_b32 v67, 0
    v_mov_b32 v68, 0
    v_mov_b32 v69, 0
    v_mov_b32 v70, 0
    v_mov_b32 v71, 0
    v_mov_b32 v72, 0
    v_mov_b32 v73, 0
    v_mov_b32 v74, 0
    v_mov_b32 v75, 0
    v_mov_b32 v76, 0
    v_mov_b32 v77, 0
    v_mov_b32 v78, 0
    v_mov_b32 v79, 0
    v_mov_b32 v80, 0
    v_mov_b32 v81, 0
    v_mov_b32 v82, 0
    v_mov_b32 v83, 0
    v_mov_b32 v84, 0
    v_mov_b32 v85, 0
    v_mov_b32 v86, 0
    v_mov_b32 v87, 0
    v_mov_b32 v88, 0
    v_mov_b32 v89, 0
    v_mov_b32 v90, 0
    v_mov_b32 v91, 0
    v_mov_b32 v92, 0
    v_mov_b32 v93, 0
    v_mov_b32 v94, 0
    v_mov_b32 v95, 0
    v_mov_b32 v96, 0
    v_mov_b32 v97, 0
    v_mov_b32 v98, 0
    v_mov_b32 v99, 0
    v_mov_b32 v100, 0
    v_mov_b32 v101, 0
    v_mov_b32 v102, 0
    v_mov_b32 v103, 0
    v_mov_b32 v104, 0
    v_mov_b32 v105, 0
    v_mov_b32 v106, 0
    v_mov_b32 v107, 0
    v_mov_b32 v108, 0
    v_mov_b32 v109, 0
    v_mov_b32 v110, 0
    v_mov_b32 v111, 0
    v_mov_b32 v112, 0
    v_mov_b32 v113, 0
    v_mov_b32 v114, 0
    v_mov_b32 v115, 0
    v_mov_b32 v116, 0
    v_mov_b32 v117, 0
    v_mov_b32 v118, 0
    v_mov_b32 v119, 0
    v_mov_b32 v120, 0
    v_mov_b32 v121, 0
    v_mov_b32 v122, 0
    v_mov_b32 v123, 0
    v_mov_b32 v124, 0
    v_mov_b32 v125, 0
    v_mov_b32 v126, 0
    v_mov_b32 v127, 0
    s_mov_b32 s35, 8192
    v_lshrrev_b32 v1, 3, v0
    v_and_b32 v2, 7, v0
    v_add_u32 v1, s32, v1
    v_add_u32 v3, 0, v1
    v_mul_lo_u32 v3, v3, s35
    v_lshl_add_u32 v4, v2, 4, v3
    v_add_u32 v3, 32, v1
    v_mul_lo_u32 v3, v3, s35
    v_lshl_add_u32 v5, v2, 4, v3
    v_add_u32 v3, 64, v1
    v_mul_lo_u32 v3, v3, s35
    v_lshl_add_u32 v6, v2, 4, v3
    v_add_u32 v3, 96, v1
    v_mul_lo_u32 v3, v3, s35
    v_lshl_add_u32 v7, v2, 4, v3
    v_lshrrev_b32 v1, 3, v0
    v_and_b32 v2, 7, v0
    v_add_u32 v3, 0, v1
    v_mul_lo_u32 v3, v3, s36
    v_lshl_add_u32 v3, v2, 4, v3
    v_add_u32 v8, s34, v3
    v_add_u32 v3, 32, v1
    v_mul_lo_u32 v3, v3, s36
    v_lshl_add_u32 v3, v2, 4, v3
    v_add_u32 v9, s34, v3
    s_mov_b32 s37, 75497472
    s_mov_b32 s38, 0
    buffer_load_dwordx4 v[128:131], v4, s[8:11], s37 offen
    buffer_load_dwordx4 v[132:135], v5, s[8:11], s37 offen
    buffer_load_dwordx4 v[136:139], v6, s[8:11], s37 offen
    buffer_load_dwordx4 v[140:143], v7, s[8:11], s37 offen
    buffer_load_dwordx4 v[144:147], v8, s[12:15], s38 offen
    buffer_load_dwordx4 v[148:151], v9, s[12:15], s38 offen
    s_add_u32 s37, s37, 128
    s_add_u32 s38, s38, 131072
    buffer_load_dwordx4 v[228:231], v4, s[8:11], s37 offen
    buffer_load_dwordx4 v[232:235], v5, s[8:11], s37 offen
    buffer_load_dwordx4 v[236:239], v6, s[8:11], s37 offen
    buffer_load_dwordx4 v[240:243], v7, s[8:11], s37 offen
    buffer_load_dwordx4 v[244:247], v8, s[12:15], s38 offen
    buffer_load_dwordx4 v[248:251], v9, s[12:15], s38 offen
    s_waitcnt vmcnt(6)
    ds_write_b128 v12, v[128:131] offset:0
    ds_write_b128 v12, v[132:135] offset:5120
    ds_write_b128 v12, v[136:139] offset:10240
    ds_write_b128 v12, v[140:143] offset:15360
    ds_write_b128 v13, v[144:147] offset:0
    ds_write_b128 v13, v[148:151] offset:5120
    s_waitcnt lgkmcnt(0)
    s_barrier
    s_mov_b32 s43, 32
gk_11:
    s_cmp_eq_u32 s43, 1
    s_cbranch_scc1 gl_12a
    s_add_u32 s37, s37, 128
    s_add_u32 s38, s38, 131072
    buffer_load_dwordx4 v[128:131], v4, s[8:11], s37 offen
    buffer_load_dwordx4 v[132:135], v5, s[8:11], s37 offen
    buffer_load_dwordx4 v[136:139], v6, s[8:11], s37 offen
    buffer_load_dwordx4 v[140:143], v7, s[8:11], s37 offen
    buffer_load_dwordx4 v[144:147], v8, s[12:15], s38 offen
    buffer_load_dwordx4 v[148:151], v9, s[12:15], s38 offen
gl_12a:
    ds_read_b64_tr_b16 v[160:161], v15 offset:0
    ds_read_b64_tr_b16 v[162:163], v15 offset:640
    ds_read_b64_tr_b16 v[164:165], v15 offset:32
    ds_read_b64_tr_b16 v[166:167], v15 offset:672
    ds_read_b128 v[192:195], v14 offset:0
    ds_read_b128 v[196:199], v14 offset:2560
    ds_read_b128 v[200:203], v14 offset:5120
    ds_read_b128 v[204:207], v14 offset:7680
    ds_read_b64_tr_b16 v[176:177], v15 offset:5120
    ds_read_b64_tr_b16 v[178:179], v15 offset:5760
    ds_read_b64_tr_b16 v[180:181], v15 offset:5152
    ds_read_b64_tr_b16 v[182:183], v15 offset:5792
    ds_read_b128 v[208:211], v14 offset:64
    ds_read_b128 v[212:215], v14 offset:2624
    ds_read_b128 v[216:219], v14 offset:5184
    ds_read_b128 v[220:223], v14 offset:7744
    s_waitcnt lgkmcnt(8)
    v_mfma_f32_16x16x32_bf16 v[64:67], v[160:163], v[192:195], v[64:67]
    v_mfma_f32_16x16x32_bf16 v[68:71], v[160:163], v[196:199], v[68:71]
    v_mfma_f32_16x16x32_bf16 v[72:75], v[160:163], v[200:203], v[72:75]
    v_mfma_f32_16x16x32_bf16 v[76:79], v[160:163], v[204:207], v[76:79]
    v_mfma_f32_16x16x32_bf16 v[80:83], v[164:167], v[192:195], v[80:83]
    v_mfma_f32_16x16x32_bf16 v[84:87], v[164:167], v[196:199], v[84:87]
    v_mfma_f32_16x16x32_bf16 v[88:91], v[164:167], v[200:203], v[88:91]
    v_mfma_f32_16x16x32_bf16 v[92:95], v[164:167], v[204:207], v[92:95]
    s_waitcnt lgkmcnt(0)
    v_mfma_f32_16x16x32_bf16 v[64:67], v[176:179], v[208:211], v[64:67]
    v_mfma_f32_16x16x32_bf16 v[68:71], v[176:179], v[212:215], v[68:71]
    v_mfma_f32_16x16x32_bf16 v[72:75], v[176:179], v[216:219], v[72:75]
    v_mfma_f32_16x16x32_bf16 v[76:79], v[176:179], v[220:223], v[76:79]
    v_mfma_f32_16x16x32_bf16 v[80:83], v[180:183], v[208:211], v[80:83]
    v_mfma_f32_16x16x32_bf16 v[84:87], v[180:183], v[212:215], v[84:87]
    v_mfma_f32_16x16x32_bf16 v[88:91], v[180:183], v[216:219], v[88:91]
    v_mfma_f32_16x16x32_bf16 v[92:95], v[180:183], v[220:223], v[92:95]
    s_cmp_eq_u32 s43, 1
    s_cbranch_scc1 gl_12b
    s_waitcnt vmcnt(6)
    ds_write_b128 v224, v[228:231] offset:0
    ds_write_b128 v224, v[232:235] offset:5120
    ds_write_b128 v224, v[236:239] offset:10240
    ds_write_b128 v224, v[240:243] offset:15360
    ds_write_b128 v225, v[244:247] offset:0
    ds_write_b128 v225, v[248:251] offset:5120
    s_waitcnt lgkmcnt(0)
    s_branch gl_12c
gl_12b:
    s_waitcnt vmcnt(0)
    ds_write_b128 v224, v[228:231] offset:0
    ds_write_b128 v224, v[232:235] offset:5120
    ds_write_b128 v224, v[236:239] offset:10240
    ds_write_b128 v224, v[240:243] offset:15360
    ds_write_b128 v225, v[244:247] offset:0
    ds_write_b128 v225, v[248:251] offset:5120
    s_waitcnt lgkmcnt(0)
gl_12c:
    s_barrier
    s_cmp_eq_u32 s43, 1
    s_cbranch_scc1 gl_13a
    s_add_u32 s37, s37, 128
    s_add_u32 s38, s38, 131072
    buffer_load_dwordx4 v[228:231], v4, s[8:11], s37 offen
    buffer_load_dwordx4 v[232:235], v5, s[8:11], s37 offen
    buffer_load_dwordx4 v[236:239], v6, s[8:11], s37 offen
    buffer_load_dwordx4 v[240:243], v7, s[8:11], s37 offen
    buffer_load_dwordx4 v[244:247], v8, s[12:15], s38 offen
    buffer_load_dwordx4 v[248:251], v9, s[12:15], s38 offen
gl_13a:
    ds_read_b64_tr_b16 v[160:161], v227 offset:0
    ds_read_b64_tr_b16 v[162:163], v227 offset:640
    ds_read_b64_tr_b16 v[164:165], v227 offset:32
    ds_read_b64_tr_b16 v[166:167], v227 offset:672
    ds_read_b128 v[192:195], v226 offset:0
    ds_read_b128 v[196:199], v226 offset:2560
    ds_read_b128 v[200:203], v226 offset:5120
    ds_read_b128 v[204:207], v226 offset:7680
    ds_read_b64_tr_b16 v[176:177], v227 offset:5120
    ds_read_b64_tr_b16 v[178:179], v227 offset:5760
    ds_read_b64_tr_b16 v[180:181], v227 offset:5152
    ds_read_b64_tr_b16 v[182:183], v227 offset:5792
    ds_read_b128 v[208:211], v226 offset:64
    ds_read_b128 v[212:215], v226 offset:2624
    ds_read_b128 v[216:219], v226 offset:5184
    ds_read_b128 v[220:223], v226 offset:7744
    s_waitcnt lgkmcnt(8)
    v_mfma_f32_16x16x32_bf16 v[64:67], v[160:163], v[192:195], v[64:67]
    v_mfma_f32_16x16x32_bf16 v[68:71], v[160:163], v[196:199], v[68:71]
    v_mfma_f32_16x16x32_bf16 v[72:75], v[160:163], v[200:203], v[72:75]
    v_mfma_f32_16x16x32_bf16 v[76:79], v[160:163], v[204:207], v[76:79]
    v_mfma_f32_16x16x32_bf16 v[80:83], v[164:167], v[192:195], v[80:83]
    v_mfma_f32_16x16x32_bf16 v[84:87], v[164:167], v[196:199], v[84:87]
    v_mfma_f32_16x16x32_bf16 v[88:91], v[164:167], v[200:203], v[88:91]
    v_mfma_f32_16x16x32_bf16 v[92:95], v[164:167], v[204:207], v[92:95]
    s_waitcnt lgkmcnt(0)
    v_mfma_f32_16x16x32_bf16 v[64:67], v[176:179], v[208:211], v[64:67]
    v_mfma_f32_16x16x32_bf16 v[68:71], v[176:179], v[212:215], v[68:71]
    v_mfma_f32_16x16x32_bf16 v[72:75], v[176:179], v[216:219], v[72:75]
    v_mfma_f32_16x16x32_bf16 v[76:79], v[176:179], v[220:223], v[76:79]
    v_mfma_f32_16x16x32_bf16 v[80:83], v[180:183], v[208:211], v[80:83]
    v_mfma_f32_16x16x32_bf16 v[84:87], v[180:183], v[212:215], v[84:87]
    v_mfma_f32_16x16x32_bf16 v[88:91], v[180:183], v[216:219], v[88:91]
    v_mfma_f32_16x16x32_bf16 v[92:95], v[180:183], v[220:223], v[92:95]
    s_cmp_eq_u32 s43, 1
    s_cbranch_scc1 gl_13b
    s_waitcnt vmcnt(6)
    ds_write_b128 v12, v[128:131] offset:0
    ds_write_b128 v12, v[132:135] offset:5120
    ds_write_b128 v12, v[136:139] offset:10240
    ds_write_b128 v12, v[140:143] offset:15360
    ds_write_b128 v13, v[144:147] offset:0
    ds_write_b128 v13, v[148:151] offset:5120
    s_waitcnt lgkmcnt(0)
    s_branch gl_13c
gl_13b:
gl_13c:
    s_barrier
    s_sub_u32 s43, s43, 1
    s_cmp_lg_u32 s43, 0
    s_cbranch_scc1 gk_11
    s_nop 7
    s_nop 7
    v_lshrrev_b32 v1, 6, v0
    v_and_b32 v2, 1, v1
    v_lshrrev_b32 v3, 1, v1
    v_and_b32 v16, 63, v0
    v_and_b32 v17, 15, v16
    v_lshrrev_b32 v18, 4, v16
    v_lshl_add_u32 v19, v2, 6, v17
    v_add_u32 v19, s32, v19
    v_lshlrev_b32 v19, 11, v19
    v_lshlrev_b32 v20, 2, v18
    v_lshl_add_u32 v20, v3, 5, v20
    v_lshlrev_b32 v20, 1, v20
    v_add_u32 v20, s34, v20
    v_add_u32 v19, v19, v20
    s_mov_b32 s45, 0
    s_mov_b32 s46, 109051904
    buffer_load_dwordx2 v[24:25], v19, s[20:23], s45 offen offset:0
    buffer_load_dwordx2 v[32:33], v19, s[8:11], s46 offen offset:0
    buffer_load_dwordx2 v[26:27], v19, s[20:23], s45 offen offset:32
    buffer_load_dwordx2 v[34:35], v19, s[8:11], s46 offen offset:32
    s_waitcnt vmcnt(0)
    v_lshlrev_b32 v48, 16, v24
    v_and_b32 v49, 0xffff0000, v24
    v_lshlrev_b32 v50, 16, v25
    v_and_b32 v51, 0xffff0000, v25
    v_lshlrev_b32 v56, 16, v32
    v_and_b32 v57, 0xffff0000, v32
    v_lshlrev_b32 v58, 16, v33
    v_and_b32 v59, 0xffff0000, v33
    v_cvt_pk_bf16_f32 v21, v64, v64
    v_lshlrev_b32 v64, 16, v21
    v_add_f32 v64, v64, v48
    v_cvt_pk_bf16_f32 v21, v64, v64
    v_lshlrev_b32 v64, 16, v21
    v_add_f32 v64, v64, v56
    v_cvt_pk_bf16_f32 v21, v65, v65
    v_lshlrev_b32 v65, 16, v21
    v_add_f32 v65, v65, v49
    v_cvt_pk_bf16_f32 v21, v65, v65
    v_lshlrev_b32 v65, 16, v21
    v_add_f32 v65, v65, v57
    v_cvt_pk_bf16_f32 v21, v66, v66
    v_lshlrev_b32 v66, 16, v21
    v_add_f32 v66, v66, v50
    v_cvt_pk_bf16_f32 v21, v66, v66
    v_lshlrev_b32 v66, 16, v21
    v_add_f32 v66, v66, v58
    v_cvt_pk_bf16_f32 v21, v67, v67
    v_lshlrev_b32 v67, 16, v21
    v_add_f32 v67, v67, v51
    v_cvt_pk_bf16_f32 v21, v67, v67
    v_lshlrev_b32 v67, 16, v21
    v_add_f32 v67, v67, v59
    v_cvt_pk_bf16_f32 v52, v64, v65
    v_cvt_pk_bf16_f32 v53, v66, v67
    buffer_store_dwordx2 v[52:53], v19, s[28:31], s45 offen offset:0
    s_nop 1
    v_lshlrev_b32 v48, 16, v26
    v_and_b32 v49, 0xffff0000, v26
    v_lshlrev_b32 v50, 16, v27
    v_and_b32 v51, 0xffff0000, v27
    v_lshlrev_b32 v56, 16, v34
    v_and_b32 v57, 0xffff0000, v34
    v_lshlrev_b32 v58, 16, v35
    v_and_b32 v59, 0xffff0000, v35
    v_cvt_pk_bf16_f32 v21, v80, v80
    v_lshlrev_b32 v80, 16, v21
    v_add_f32 v80, v80, v48
    v_cvt_pk_bf16_f32 v21, v80, v80
    v_lshlrev_b32 v80, 16, v21
    v_add_f32 v80, v80, v56
    v_cvt_pk_bf16_f32 v21, v81, v81
    v_lshlrev_b32 v81, 16, v21
    v_add_f32 v81, v81, v49
    v_cvt_pk_bf16_f32 v21, v81, v81
    v_lshlrev_b32 v81, 16, v21
    v_add_f32 v81, v81, v57
    v_cvt_pk_bf16_f32 v21, v82, v82
    v_lshlrev_b32 v82, 16, v21
    v_add_f32 v82, v82, v50
    v_cvt_pk_bf16_f32 v21, v82, v82
    v_lshlrev_b32 v82, 16, v21
    v_add_f32 v82, v82, v58
    v_cvt_pk_bf16_f32 v21, v83, v83
    v_lshlrev_b32 v83, 16, v21
    v_add_f32 v83, v83, v51
    v_cvt_pk_bf16_f32 v21, v83, v83
    v_lshlrev_b32 v83, 16, v21
    v_add_f32 v83, v83, v59
    v_cvt_pk_bf16_f32 v52, v80, v81
    v_cvt_pk_bf16_f32 v53, v82, v83
    buffer_store_dwordx2 v[52:53], v19, s[28:31], s45 offen offset:32
    s_nop 1
    s_add_u32 s45, s45, 32768
    s_add_u32 s46, s46, 32768
    buffer_load_dwordx2 v[24:25], v19, s[20:23], s45 offen offset:0
    buffer_load_dwordx2 v[32:33], v19, s[8:11], s46 offen offset:0
    buffer_load_dwordx2 v[26:27], v19, s[20:23], s45 offen offset:32
    buffer_load_dwordx2 v[34:35], v19, s[8:11], s46 offen offset:32
    s_waitcnt vmcnt(0)
    v_lshlrev_b32 v48, 16, v24
    v_and_b32 v49, 0xffff0000, v24
    v_lshlrev_b32 v50, 16, v25
    v_and_b32 v51, 0xffff0000, v25
    v_lshlrev_b32 v56, 16, v32
    v_and_b32 v57, 0xffff0000, v32
    v_lshlrev_b32 v58, 16, v33
    v_and_b32 v59, 0xffff0000, v33
    v_cvt_pk_bf16_f32 v21, v68, v68
    v_lshlrev_b32 v68, 16, v21
    v_add_f32 v68, v68, v48
    v_cvt_pk_bf16_f32 v21, v68, v68
    v_lshlrev_b32 v68, 16, v21
    v_add_f32 v68, v68, v56
    v_cvt_pk_bf16_f32 v21, v69, v69
    v_lshlrev_b32 v69, 16, v21
    v_add_f32 v69, v69, v49
    v_cvt_pk_bf16_f32 v21, v69, v69
    v_lshlrev_b32 v69, 16, v21
    v_add_f32 v69, v69, v57
    v_cvt_pk_bf16_f32 v21, v70, v70
    v_lshlrev_b32 v70, 16, v21
    v_add_f32 v70, v70, v50
    v_cvt_pk_bf16_f32 v21, v70, v70
    v_lshlrev_b32 v70, 16, v21
    v_add_f32 v70, v70, v58
    v_cvt_pk_bf16_f32 v21, v71, v71
    v_lshlrev_b32 v71, 16, v21
    v_add_f32 v71, v71, v51
    v_cvt_pk_bf16_f32 v21, v71, v71
    v_lshlrev_b32 v71, 16, v21
    v_add_f32 v71, v71, v59
    v_cvt_pk_bf16_f32 v52, v68, v69
    v_cvt_pk_bf16_f32 v53, v70, v71
    buffer_store_dwordx2 v[52:53], v19, s[28:31], s45 offen offset:0
    s_nop 1
    v_lshlrev_b32 v48, 16, v26
    v_and_b32 v49, 0xffff0000, v26
    v_lshlrev_b32 v50, 16, v27
    v_and_b32 v51, 0xffff0000, v27
    v_lshlrev_b32 v56, 16, v34
    v_and_b32 v57, 0xffff0000, v34
    v_lshlrev_b32 v58, 16, v35
    v_and_b32 v59, 0xffff0000, v35
    v_cvt_pk_bf16_f32 v21, v84, v84
    v_lshlrev_b32 v84, 16, v21
    v_add_f32 v84, v84, v48
    v_cvt_pk_bf16_f32 v21, v84, v84
    v_lshlrev_b32 v84, 16, v21
    v_add_f32 v84, v84, v56
    v_cvt_pk_bf16_f32 v21, v85, v85
    v_lshlrev_b32 v85, 16, v21
    v_add_f32 v85, v85, v49
    v_cvt_pk_bf16_f32 v21, v85, v85
    v_lshlrev_b32 v85, 16, v21
    v_add_f32 v85, v85, v57
    v_cvt_pk_bf16_f32 v21, v86, v86
    v_lshlrev_b32 v86, 16, v21
    v_add_f32 v86, v86, v50
    v_cvt_pk_bf16_f32 v21, v86, v86
    v_lshlrev_b32 v86, 16, v21
    v_add_f32 v86, v86, v58
    v_cvt_pk_bf16_f32 v21, v87, v87
    v_lshlrev_b32 v87, 16, v21
    v_add_f32 v87, v87, v51
    v_cvt_pk_bf16_f32 v21, v87, v87
    v_lshlrev_b32 v87, 16, v21
    v_add_f32 v87, v87, v59
    v_cvt_pk_bf16_f32 v52, v84, v85
    v_cvt_pk_bf16_f32 v53, v86, v87
    buffer_store_dwordx2 v[52:53], v19, s[28:31], s45 offen offset:32
    s_nop 1
    s_add_u32 s45, s45, 32768
    s_add_u32 s46, s46, 32768
    buffer_load_dwordx2 v[24:25], v19, s[20:23], s45 offen offset:0
    buffer_load_dwordx2 v[32:33], v19, s[8:11], s46 offen offset:0
    buffer_load_dwordx2 v[26:27], v19, s[20:23], s45 offen offset:32
    buffer_load_dwordx2 v[34:35], v19, s[8:11], s46 offen offset:32
    s_waitcnt vmcnt(0)
    v_lshlrev_b32 v48, 16, v24
    v_and_b32 v49, 0xffff0000, v24
    v_lshlrev_b32 v50, 16, v25
    v_and_b32 v51, 0xffff0000, v25
    v_lshlrev_b32 v56, 16, v32
    v_and_b32 v57, 0xffff0000, v32
    v_lshlrev_b32 v58, 16, v33
    v_and_b32 v59, 0xffff0000, v33
    v_cvt_pk_bf16_f32 v21, v72, v72
    v_lshlrev_b32 v72, 16, v21
    v_add_f32 v72, v72, v48
    v_cvt_pk_bf16_f32 v21, v72, v72
    v_lshlrev_b32 v72, 16, v21
    v_add_f32 v72, v72, v56
    v_cvt_pk_bf16_f32 v21, v73, v73
    v_lshlrev_b32 v73, 16, v21
    v_add_f32 v73, v73, v49
    v_cvt_pk_bf16_f32 v21, v73, v73
    v_lshlrev_b32 v73, 16, v21
    v_add_f32 v73, v73, v57
    v_cvt_pk_bf16_f32 v21, v74, v74
    v_lshlrev_b32 v74, 16, v21
    v_add_f32 v74, v74, v50
    v_cvt_pk_bf16_f32 v21, v74, v74
    v_lshlrev_b32 v74, 16, v21
    v_add_f32 v74, v74, v58
    v_cvt_pk_bf16_f32 v21, v75, v75
    v_lshlrev_b32 v75, 16, v21
    v_add_f32 v75, v75, v51
    v_cvt_pk_bf16_f32 v21, v75, v75
    v_lshlrev_b32 v75, 16, v21
    v_add_f32 v75, v75, v59
    v_cvt_pk_bf16_f32 v52, v72, v73
    v_cvt_pk_bf16_f32 v53, v74, v75
    buffer_store_dwordx2 v[52:53], v19, s[28:31], s45 offen offset:0
    s_nop 1
    v_lshlrev_b32 v48, 16, v26
    v_and_b32 v49, 0xffff0000, v26
    v_lshlrev_b32 v50, 16, v27
    v_and_b32 v51, 0xffff0000, v27
    v_lshlrev_b32 v56, 16, v34
    v_and_b32 v57, 0xffff0000, v34
    v_lshlrev_b32 v58, 16, v35
    v_and_b32 v59, 0xffff0000, v35
    v_cvt_pk_bf16_f32 v21, v88, v88
    v_lshlrev_b32 v88, 16, v21
    v_add_f32 v88, v88, v48
    v_cvt_pk_bf16_f32 v21, v88, v88
    v_lshlrev_b32 v88, 16, v21
    v_add_f32 v88, v88, v56
    v_cvt_pk_bf16_f32 v21, v89, v89
    v_lshlrev_b32 v89, 16, v21
    v_add_f32 v89, v89, v49
    v_cvt_pk_bf16_f32 v21, v89, v89
    v_lshlrev_b32 v89, 16, v21
    v_add_f32 v89, v89, v57
    v_cvt_pk_bf16_f32 v21, v90, v90
    v_lshlrev_b32 v90, 16, v21
    v_add_f32 v90, v90, v50
    v_cvt_pk_bf16_f32 v21, v90, v90
    v_lshlrev_b32 v90, 16, v21
    v_add_f32 v90, v90, v58
    v_cvt_pk_bf16_f32 v21, v91, v91
    v_lshlrev_b32 v91, 16, v21
    v_add_f32 v91, v91, v51
    v_cvt_pk_bf16_f32 v21, v91, v91
    v_lshlrev_b32 v91, 16, v21
    v_add_f32 v91, v91, v59
    v_cvt_pk_bf16_f32 v52, v88, v89
    v_cvt_pk_bf16_f32 v53, v90, v91
    buffer_store_dwordx2 v[52:53], v19, s[28:31], s45 offen offset:32
    s_nop 1
    s_add_u32 s45, s45, 32768
    s_add_u32 s46, s46, 32768
    buffer_load_dwordx2 v[24:25], v19, s[20:23], s45 offen offset:0
    buffer_load_dwordx2 v[32:33], v19, s[8:11], s46 offen offset:0
    buffer_load_dwordx2 v[26:27], v19, s[20:23], s45 offen offset:32
    buffer_load_dwordx2 v[34:35], v19, s[8:11], s46 offen offset:32
    s_waitcnt vmcnt(0)
    v_lshlrev_b32 v48, 16, v24
    v_and_b32 v49, 0xffff0000, v24
    v_lshlrev_b32 v50, 16, v25
    v_and_b32 v51, 0xffff0000, v25
    v_lshlrev_b32 v56, 16, v32
    v_and_b32 v57, 0xffff0000, v32
    v_lshlrev_b32 v58, 16, v33
    v_and_b32 v59, 0xffff0000, v33
    v_cvt_pk_bf16_f32 v21, v76, v76
    v_lshlrev_b32 v76, 16, v21
    v_add_f32 v76, v76, v48
    v_cvt_pk_bf16_f32 v21, v76, v76
    v_lshlrev_b32 v76, 16, v21
    v_add_f32 v76, v76, v56
    v_cvt_pk_bf16_f32 v21, v77, v77
    v_lshlrev_b32 v77, 16, v21
    v_add_f32 v77, v77, v49
    v_cvt_pk_bf16_f32 v21, v77, v77
    v_lshlrev_b32 v77, 16, v21
    v_add_f32 v77, v77, v57
    v_cvt_pk_bf16_f32 v21, v78, v78
    v_lshlrev_b32 v78, 16, v21
    v_add_f32 v78, v78, v50
    v_cvt_pk_bf16_f32 v21, v78, v78
    v_lshlrev_b32 v78, 16, v21
    v_add_f32 v78, v78, v58
    v_cvt_pk_bf16_f32 v21, v79, v79
    v_lshlrev_b32 v79, 16, v21
    v_add_f32 v79, v79, v51
    v_cvt_pk_bf16_f32 v21, v79, v79
    v_lshlrev_b32 v79, 16, v21
    v_add_f32 v79, v79, v59
    v_cvt_pk_bf16_f32 v52, v76, v77
    v_cvt_pk_bf16_f32 v53, v78, v79
    buffer_store_dwordx2 v[52:53], v19, s[28:31], s45 offen offset:0
    s_nop 1
    v_lshlrev_b32 v48, 16, v26
    v_and_b32 v49, 0xffff0000, v26
    v_lshlrev_b32 v50, 16, v27
    v_and_b32 v51, 0xffff0000, v27
    v_lshlrev_b32 v56, 16, v34
    v_and_b32 v57, 0xffff0000, v34
    v_lshlrev_b32 v58, 16, v35
    v_and_b32 v59, 0xffff0000, v35
    v_cvt_pk_bf16_f32 v21, v92, v92
    v_lshlrev_b32 v92, 16, v21
    v_add_f32 v92, v92, v48
    v_cvt_pk_bf16_f32 v21, v92, v92
    v_lshlrev_b32 v92, 16, v21
    v_add_f32 v92, v92, v56
    v_cvt_pk_bf16_f32 v21, v93, v93
    v_lshlrev_b32 v93, 16, v21
    v_add_f32 v93, v93, v49
    v_cvt_pk_bf16_f32 v21, v93, v93
    v_lshlrev_b32 v93, 16, v21
    v_add_f32 v93, v93, v57
    v_cvt_pk_bf16_f32 v21, v94, v94
    v_lshlrev_b32 v94, 16, v21
    v_add_f32 v94, v94, v50
    v_cvt_pk_bf16_f32 v21, v94, v94
    v_lshlrev_b32 v94, 16, v21
    v_add_f32 v94, v94, v58
    v_cvt_pk_bf16_f32 v21, v95, v95
    v_lshlrev_b32 v95, 16, v21
    v_add_f32 v95, v95, v51
    v_cvt_pk_bf16_f32 v21, v95, v95
    v_lshlrev_b32 v95, 16, v21
    v_add_f32 v95, v95, v59
    v_cvt_pk_bf16_f32 v52, v92, v93
    v_cvt_pk_bf16_f32 v53, v94, v95
    buffer_store_dwordx2 v[52:53], v19, s[28:31], s45 offen offset:32
    s_nop 1
    s_add_u32 s45, s45, 32768
    s_add_u32 s46, s46, 32768
g2_done:
    s_endpgm
.section .rodata,"a"
.p2align 6
.amdhsa_kernel prep_kernel
  .amdhsa_next_free_vgpr 48
  .amdhsa_next_free_sgpr 16
  .amdhsa_accum_offset 48
  .amdhsa_group_segment_fixed_size 0
  .amdhsa_kernarg_size 120
  .amdhsa_user_sgpr_count 2
  .amdhsa_user_sgpr_kernarg_segment_ptr 1
  .amdhsa_system_sgpr_workgroup_id_x 1
.end_amdhsa_kernel

.amdhsa_kernel chain_kernel
  .amdhsa_next_free_vgpr 256
  .amdhsa_next_free_sgpr 96
  .amdhsa_accum_offset 256
  .amdhsa_group_segment_fixed_size 0
  .amdhsa_kernarg_size 120
  .amdhsa_user_sgpr_count 2
  .amdhsa_user_sgpr_kernarg_segment_ptr 1
  .amdhsa_system_sgpr_workgroup_id_x 1
.end_amdhsa_kernel

.amdhsa_kernel attn_kernel
  .amdhsa_next_free_vgpr 144
  .amdhsa_next_free_sgpr 32
  .amdhsa_accum_offset 144
  .amdhsa_group_segment_fixed_size 0
  .amdhsa_kernarg_size 120
  .amdhsa_user_sgpr_count 2
  .amdhsa_user_sgpr_kernarg_segment_ptr 1
  .amdhsa_system_sgpr_workgroup_id_x 1
.end_amdhsa_kernel

.amdhsa_kernel gemm2_kernel
  .amdhsa_next_free_vgpr 252
  .amdhsa_next_free_sgpr 64
  .amdhsa_accum_offset 252
  .amdhsa_group_segment_fixed_size 0
  .amdhsa_kernarg_size 120
  .amdhsa_user_sgpr_count 2
  .amdhsa_user_sgpr_kernarg_segment_ptr 1
  .amdhsa_system_sgpr_workgroup_id_x 1
.end_amdhsa_kernel
```
